```python
import torch

def _softmax(x, axis=-1):
    return torch.softmax(x, dim=axis)
def _gelu(x):
    return torch.nn.functional.gelu(x, approximate="tanh")
def _silu(x):
    return torch.nn.functional.silu(x)
def _sigmoid(x):
    return torch.sigmoid(x)
def _layernorm(x, axis=-1, eps=1e-5):
    m = x.mean(dim=axis, keepdim=True)
    v = x.var(dim=axis, keepdim=True, unbiased=False)
    return (x - m) / torch.sqrt(v + eps)
def _scatter_add(tgt, idx, src, axis=0):
    return tgt.clone().index_add_(axis, idx, src)
def _segment_sum(src, seg, n):
    out = torch.zeros((n,) + src.shape[1:], dtype=src.dtype)
    return out.index_add_(0, seg, src)
def _pad(x, pw):
    flat = tuple(v for pair in reversed(pw) for v in pair)
    return torch.nn.functional.pad(x, flat)

kernel_name = 'parallel_sum__sliding_block__moe_arch_mod__prompt'

def setup_inputs():

    _w = (lambda a: (lambda t: t.to(torch.bfloat16) if t.is_floating_point() else t)(torch.as_tensor(a)))
    def _A_setup():
        B, S, D = 1, 2048, 448
        return {
            "x": _w((lambda *s: torch.randn(*s, dtype=torch.bfloat16) * 0.05)(B, S, D)),
            "wqkv": _w((lambda *s: torch.randn(*s, dtype=torch.bfloat16) * 0.05)(D, 3 * D)),
            "wo": _w((lambda *s: torch.randn(*s, dtype=torch.bfloat16) * 0.05)(D, D)),
        }
    _A_in = _A_setup()

    def _B_setup():
        B, S, D, F, C = 1, 2048, 448, 1792, 2
        return {
            "x": _w((lambda *s: torch.randn(*s, dtype=torch.bfloat16) * 0.05)(B, S, D)),
            "w_r": _w((lambda *s: torch.randn(*s, dtype=torch.bfloat16) * 0.05)(D)),
            "w_gate": _w((lambda *s: torch.randn(*s, dtype=torch.bfloat16) * 0.05)(D, F)),
            "w_up": _w((lambda *s: torch.randn(*s, dtype=torch.bfloat16) * 0.05)(D, F)),
            "w_down": _w((lambda *s: torch.randn(*s, dtype=torch.bfloat16) * 0.05)(F, D)),
        }
    _B_in = _B_setup()

    return {
        "A_x": _A_in["x"],
        "A_wqkv": _A_in["wqkv"],
        "A_wo": _A_in["wo"],
        "B_x": _B_in["x"],
        "B_w_r": _B_in["w_r"],
        "B_w_gate": _B_in["w_gate"],
        "B_w_up": _B_in["w_up"],
        "B_w_down": _B_in["w_down"],
    }

def reference(A_x, A_wqkv, A_wo, B_x, B_w_r, B_w_gate, B_w_up, B_w_down):
    def _A_ref(x, wqkv, wo):
        B, S, D = x.shape
        H = 16; Dh = D // H; W = 256
        qkv = (lambda x, *d: x.permute(*d))((x @ wqkv).reshape(B, S, 3, H, Dh), 2, 0, 3, 1, 4)
        q, k, v = qkv[0], qkv[1], qkv[2]
        scores = torch.einsum("bhqd,bhkd->bhqk", q, k) * (Dh ** -0.5)
        idx = torch.arange(S)
        mask = (idx[:, None] - idx[None, :] >= 0) & (idx[:, None] - idx[None, :] < W)
        scores = torch.where(mask[None, None], scores, -1e9)
        p = _softmax(scores, axis=-1)
        o = torch.einsum("bhqk,bhkd->bhqd", p, v)
        return (lambda x, *d: x.permute(*d))(o, 0, 2, 1, 3).reshape(B, S, D) @ wo

    def _B_ref(x, w_r, w_gate, w_up, w_down):
        B, S, D = x.shape
        C = 2
        r = x @ w_r
        idx = torch.argsort(-r, axis=-1)[:, :C]
        idx_e = (lambda x, n, axis: torch.repeat_interleave(x, n, dim=axis))(idx.reshape(B, C, 1), D, axis=2)
        x_sel = (lambda x, i, axis: torch.take_along_dim(x, i, dim=axis))(x, idx_e, axis=1)
        g = _silu(x_sel @ w_gate)
        u = x_sel @ w_up
        y = (g * u) @ w_down
        r_sel = _sigmoid((lambda x, i, axis: torch.take_along_dim(x, i, dim=axis))(r, idx, axis=1))
        y = y * r_sel.reshape(B, C, 1)
        b_off = (torch.arange(B) * S).reshape(B, 1)
        flat_idx = (idx + b_off).reshape(B * C)
        zero = (x * 0.0).reshape(B * S, D)
        upd = _scatter_add(zero, flat_idx, y.reshape(B * C, D), axis=0)
        return x + upd.reshape(B, S, D)

    x = A_x
    xn = _layernorm(x, axis=-1)
    return x + _A_ref(xn, A_wqkv, A_wo) + _B_ref(xn, B_w_r, B_w_gate, B_w_up, B_w_down)
```

```asm
; @launch kernel=k1_kernel grid=(224,1,1) block=(256,1,1) lds=137216
; @launch kernel=k2_kernel grid=(368,1,1) block=(512,1,1) lds=49152
; @launch kernel=k3_kernel grid=(252,1,1) block=(256,1,1) lds=86016
.amdgcn_target "amdgcn-amd-amdhsa--gfx950"
.text
.globl k1_kernel
.p2align 8
.type k1_kernel,@function
k1_kernel:
    s_cmp_ge_u32 s2, 224
    s_cbranch_scc1 k1_done
    s_load_dwordx4 s[36:39], s[0:1], 0
    s_load_dwordx2 s[8:9], s[0:1], 32
    s_load_dwordx2 s[10:11], s[0:1], 80
    s_and_b32 s3, s2, 7
    s_lshr_b32 s4, s2, 3
    s_mul_i32 s5, s4, 37
    s_lshr_b32 s5, s5, 8
    s_mul_i32 s6, s5, 7
    s_sub_u32 s2, s4, s6
    s_lshl_b32 s3, s3, 2
    s_add_u32 s3, s3, s5
    v_and_b32 v1, 63, v0
    v_and_b32 v2, 15, v0
    v_bfe_u32 v3, v0, 4, 2
    v_lshrrev_b32 v5, 6, v0
    s_nop 0
    v_readfirstlane_b32 s28, v5
    s_waitcnt lgkmcnt(0)
    s_mov_b32 s12, s36
    s_mov_b32 s13, s37
    s_mov_b32 s14, 0x1c0000
    s_mov_b32 s15, 0x00020000
    s_mov_b32 s16, s38
    s_mov_b32 s17, s39
    s_mov_b32 s18, 0x126000
    s_mov_b32 s19, 0x00020000
    s_mov_b32 s20, s10
    s_mov_b32 s21, s11
    s_mov_b32 s22, 0x70b000
    s_mov_b32 s23, 0x00020000
    s_mov_b32 s24, s8
    s_mov_b32 s25, s9
    s_mov_b32 s26, 0x380
    s_mov_b32 s27, 0x00020000
    s_lshl_b32 s29, s3, 6
    s_lshl_b32 s30, s28, 4
    s_add_u32 s29, s29, s30
    v_add_u32 v6, s29, v2
    s_movk_i32 s31, 896
    v_mul_lo_u32 v4, v6, s31
    v_lshl_add_u32 v4, v3, 4, v4
    buffer_load_dwordx4 v[16:19], v4, s[12:15], 0 offen offset:0
    buffer_load_dwordx4 v[20:23], v4, s[12:15], 0 offen offset:64
    buffer_load_dwordx4 v[24:27], v4, s[12:15], 0 offen offset:128
    buffer_load_dwordx4 v[28:31], v4, s[12:15], 0 offen offset:192
    buffer_load_dwordx4 v[32:35], v4, s[12:15], 0 offen offset:256
    buffer_load_dwordx4 v[36:39], v4, s[12:15], 0 offen offset:320
    buffer_load_dwordx4 v[40:43], v4, s[12:15], 0 offen offset:384
    buffer_load_dwordx4 v[44:47], v4, s[12:15], 0 offen offset:448
    buffer_load_dwordx4 v[48:51], v4, s[12:15], 0 offen offset:512
    buffer_load_dwordx4 v[52:55], v4, s[12:15], 0 offen offset:576
    buffer_load_dwordx4 v[56:59], v4, s[12:15], 0 offen offset:640
    buffer_load_dwordx4 v[60:63], v4, s[12:15], 0 offen offset:704
    buffer_load_dwordx4 v[64:67], v4, s[12:15], 0 offen offset:768
    buffer_load_dwordx4 v[68:71], v4, s[12:15], 0 offen offset:832
    v_lshrrev_b32 v7, 3, v0
    v_and_b32 v8, 7, v0
    s_movk_i32 s32, 2688
    v_mul_lo_u32 v9, v7, s32
    v_lshl_add_u32 v9, v8, 4, v9
    v_add_u32 v10, 0x15000, v9
    s_mul_i32 s33, s2, 384
    v_mul_u32_u24 v11, 416, v7
    v_lshl_add_u32 v11, v8, 4, v11
    s_add_u32 s34, s33, 0
    buffer_load_dwordx4 v[184:187], v9, s[16:19], s34 offen offset:0
    buffer_load_dwordx4 v[188:191], v9, s[16:19], s34 offen offset:128
    buffer_load_dwordx4 v[192:195], v9, s[16:19], s34 offen offset:256
    buffer_load_dwordx4 v[196:199], v10, s[16:19], s34 offen offset:0
    buffer_load_dwordx4 v[200:203], v10, s[16:19], s34 offen offset:128
    buffer_load_dwordx4 v[204:207], v10, s[16:19], s34 offen offset:256
    s_add_u32 s34, s33, 172032
    buffer_load_dwordx4 v[208:211], v9, s[16:19], s34 offen offset:0
    buffer_load_dwordx4 v[212:215], v9, s[16:19], s34 offen offset:128
    buffer_load_dwordx4 v[216:219], v9, s[16:19], s34 offen offset:256
    buffer_load_dwordx4 v[220:223], v10, s[16:19], s34 offen offset:0
    buffer_load_dwordx4 v[224:227], v10, s[16:19], s34 offen offset:128
    buffer_load_dwordx4 v[228:231], v10, s[16:19], s34 offen offset:256
    v_xor_b32 v12, 16, v1
    v_lshlrev_b32 v12, 2, v12
    v_xor_b32 v13, 32, v1
    v_lshlrev_b32 v13, 2, v13
    s_waitcnt vmcnt(25)
    v_lshlrev_b32 v72, 16, v16
    v_and_b32 v73, 0xffff0000, v16
    v_lshlrev_b32 v74, 16, v17
    v_and_b32 v75, 0xffff0000, v17
    v_lshlrev_b32 v76, 16, v18
    v_and_b32 v77, 0xffff0000, v18
    v_lshlrev_b32 v78, 16, v19
    v_and_b32 v79, 0xffff0000, v19
    s_waitcnt vmcnt(24)
    v_lshlrev_b32 v80, 16, v20
    v_and_b32 v81, 0xffff0000, v20
    v_lshlrev_b32 v82, 16, v21
    v_and_b32 v83, 0xffff0000, v21
    v_lshlrev_b32 v84, 16, v22
    v_and_b32 v85, 0xffff0000, v22
    v_lshlrev_b32 v86, 16, v23
    v_and_b32 v87, 0xffff0000, v23
    s_waitcnt vmcnt(23)
    v_lshlrev_b32 v88, 16, v24
    v_and_b32 v89, 0xffff0000, v24
    v_lshlrev_b32 v90, 16, v25
    v_and_b32 v91, 0xffff0000, v25
    v_lshlrev_b32 v92, 16, v26
    v_and_b32 v93, 0xffff0000, v26
    v_lshlrev_b32 v94, 16, v27
    v_and_b32 v95, 0xffff0000, v27
    s_waitcnt vmcnt(22)
    v_lshlrev_b32 v96, 16, v28
    v_and_b32 v97, 0xffff0000, v28
    v_lshlrev_b32 v98, 16, v29
    v_and_b32 v99, 0xffff0000, v29
    v_lshlrev_b32 v100, 16, v30
    v_and_b32 v101, 0xffff0000, v30
    v_lshlrev_b32 v102, 16, v31
    v_and_b32 v103, 0xffff0000, v31
    s_waitcnt vmcnt(21)
    v_lshlrev_b32 v104, 16, v32
    v_and_b32 v105, 0xffff0000, v32
    v_lshlrev_b32 v106, 16, v33
    v_and_b32 v107, 0xffff0000, v33
    v_lshlrev_b32 v108, 16, v34
    v_and_b32 v109, 0xffff0000, v34
    v_lshlrev_b32 v110, 16, v35
    v_and_b32 v111, 0xffff0000, v35
    s_waitcnt vmcnt(20)
    v_lshlrev_b32 v112, 16, v36
    v_and_b32 v113, 0xffff0000, v36
    v_lshlrev_b32 v114, 16, v37
    v_and_b32 v115, 0xffff0000, v37
    v_lshlrev_b32 v116, 16, v38
    v_and_b32 v117, 0xffff0000, v38
    v_lshlrev_b32 v118, 16, v39
    v_and_b32 v119, 0xffff0000, v39
    s_waitcnt vmcnt(19)
    v_lshlrev_b32 v120, 16, v40
    v_and_b32 v121, 0xffff0000, v40
    v_lshlrev_b32 v122, 16, v41
    v_and_b32 v123, 0xffff0000, v41
    v_lshlrev_b32 v124, 16, v42
    v_and_b32 v125, 0xffff0000, v42
    v_lshlrev_b32 v126, 16, v43
    v_and_b32 v127, 0xffff0000, v43
    s_waitcnt vmcnt(18)
    v_lshlrev_b32 v128, 16, v44
    v_and_b32 v129, 0xffff0000, v44
    v_lshlrev_b32 v130, 16, v45
    v_and_b32 v131, 0xffff0000, v45
    v_lshlrev_b32 v132, 16, v46
    v_and_b32 v133, 0xffff0000, v46
    v_lshlrev_b32 v134, 16, v47
    v_and_b32 v135, 0xffff0000, v47
    s_waitcnt vmcnt(17)
    v_lshlrev_b32 v136, 16, v48
    v_and_b32 v137, 0xffff0000, v48
    v_lshlrev_b32 v138, 16, v49
    v_and_b32 v139, 0xffff0000, v49
    v_lshlrev_b32 v140, 16, v50
    v_and_b32 v141, 0xffff0000, v50
    v_lshlrev_b32 v142, 16, v51
    v_and_b32 v143, 0xffff0000, v51
    s_waitcnt vmcnt(16)
    v_lshlrev_b32 v144, 16, v52
    v_and_b32 v145, 0xffff0000, v52
    v_lshlrev_b32 v146, 16, v53
    v_and_b32 v147, 0xffff0000, v53
    v_lshlrev_b32 v148, 16, v54
    v_and_b32 v149, 0xffff0000, v54
    v_lshlrev_b32 v150, 16, v55
    v_and_b32 v151, 0xffff0000, v55
    s_waitcnt vmcnt(15)
    v_lshlrev_b32 v152, 16, v56
    v_and_b32 v153, 0xffff0000, v56
    v_lshlrev_b32 v154, 16, v57
    v_and_b32 v155, 0xffff0000, v57
    v_lshlrev_b32 v156, 16, v58
    v_and_b32 v157, 0xffff0000, v58
    v_lshlrev_b32 v158, 16, v59
    v_and_b32 v159, 0xffff0000, v59
    s_waitcnt vmcnt(14)
    v_lshlrev_b32 v160, 16, v60
    v_and_b32 v161, 0xffff0000, v60
    v_lshlrev_b32 v162, 16, v61
    v_and_b32 v163, 0xffff0000, v61
    v_lshlrev_b32 v164, 16, v62
    v_and_b32 v165, 0xffff0000, v62
    v_lshlrev_b32 v166, 16, v63
    v_and_b32 v167, 0xffff0000, v63
    s_waitcnt vmcnt(13)
    v_lshlrev_b32 v168, 16, v64
    v_and_b32 v169, 0xffff0000, v64
    v_lshlrev_b32 v170, 16, v65
    v_and_b32 v171, 0xffff0000, v65
    v_lshlrev_b32 v172, 16, v66
    v_and_b32 v173, 0xffff0000, v66
    v_lshlrev_b32 v174, 16, v67
    v_and_b32 v175, 0xffff0000, v67
    s_waitcnt vmcnt(12)
    v_lshlrev_b32 v176, 16, v68
    v_and_b32 v177, 0xffff0000, v68
    v_lshlrev_b32 v178, 16, v69
    v_and_b32 v179, 0xffff0000, v69
    v_lshlrev_b32 v180, 16, v70
    v_and_b32 v181, 0xffff0000, v70
    v_lshlrev_b32 v182, 16, v71
    v_and_b32 v183, 0xffff0000, v71
    v_pk_add_f32 v[14:15], v[72:73], v[74:75]
    v_pk_add_f32 v[14:15], v[14:15], v[76:77]
    v_pk_add_f32 v[14:15], v[14:15], v[78:79]
    v_pk_add_f32 v[14:15], v[14:15], v[80:81]
    v_pk_add_f32 v[14:15], v[14:15], v[82:83]
    v_pk_add_f32 v[14:15], v[14:15], v[84:85]
    v_pk_add_f32 v[14:15], v[14:15], v[86:87]
    v_pk_add_f32 v[14:15], v[14:15], v[88:89]
    v_pk_add_f32 v[14:15], v[14:15], v[90:91]
    v_pk_add_f32 v[14:15], v[14:15], v[92:93]
    v_pk_add_f32 v[14:15], v[14:15], v[94:95]
    v_pk_add_f32 v[14:15], v[14:15], v[96:97]
    v_pk_add_f32 v[14:15], v[14:15], v[98:99]
    v_pk_add_f32 v[14:15], v[14:15], v[100:101]
    v_pk_add_f32 v[14:15], v[14:15], v[102:103]
    v_pk_add_f32 v[14:15], v[14:15], v[104:105]
    v_pk_add_f32 v[14:15], v[14:15], v[106:107]
    v_pk_add_f32 v[14:15], v[14:15], v[108:109]
    v_pk_add_f32 v[14:15], v[14:15], v[110:111]
    v_pk_add_f32 v[14:15], v[14:15], v[112:113]
    v_pk_add_f32 v[14:15], v[14:15], v[114:115]
    v_pk_add_f32 v[14:15], v[14:15], v[116:117]
    v_pk_add_f32 v[14:15], v[14:15], v[118:119]
    v_pk_add_f32 v[14:15], v[14:15], v[120:121]
    v_pk_add_f32 v[14:15], v[14:15], v[122:123]
    v_pk_add_f32 v[14:15], v[14:15], v[124:125]
    v_pk_add_f32 v[14:15], v[14:15], v[126:127]
    v_pk_add_f32 v[14:15], v[14:15], v[128:129]
    v_pk_add_f32 v[14:15], v[14:15], v[130:131]
    v_pk_add_f32 v[14:15], v[14:15], v[132:133]
    v_pk_add_f32 v[14:15], v[14:15], v[134:135]
    v_pk_add_f32 v[14:15], v[14:15], v[136:137]
    v_pk_add_f32 v[14:15], v[14:15], v[138:139]
    v_pk_add_f32 v[14:15], v[14:15], v[140:141]
    v_pk_add_f32 v[14:15], v[14:15], v[142:143]
    v_pk_add_f32 v[14:15], v[14:15], v[144:145]
    v_pk_add_f32 v[14:15], v[14:15], v[146:147]
    v_pk_add_f32 v[14:15], v[14:15], v[148:149]
    v_pk_add_f32 v[14:15], v[14:15], v[150:151]
    v_pk_add_f32 v[14:15], v[14:15], v[152:153]
    v_pk_add_f32 v[14:15], v[14:15], v[154:155]
    v_pk_add_f32 v[14:15], v[14:15], v[156:157]
    v_pk_add_f32 v[14:15], v[14:15], v[158:159]
    v_pk_add_f32 v[14:15], v[14:15], v[160:161]
    v_pk_add_f32 v[14:15], v[14:15], v[162:163]
    v_pk_add_f32 v[14:15], v[14:15], v[164:165]
    v_pk_add_f32 v[14:15], v[14:15], v[166:167]
    v_pk_add_f32 v[14:15], v[14:15], v[168:169]
    v_pk_add_f32 v[14:15], v[14:15], v[170:171]
    v_pk_add_f32 v[14:15], v[14:15], v[172:173]
    v_pk_add_f32 v[14:15], v[14:15], v[174:175]
    v_pk_add_f32 v[14:15], v[14:15], v[176:177]
    v_pk_add_f32 v[14:15], v[14:15], v[178:179]
    v_pk_add_f32 v[14:15], v[14:15], v[180:181]
    v_pk_add_f32 v[14:15], v[14:15], v[182:183]
    v_add_f32 v14, v14, v15
    ds_bpermute_b32 v15, v12, v14
    s_waitcnt lgkmcnt(0)
    v_add_f32 v14, v14, v15
    ds_bpermute_b32 v15, v13, v14
    s_waitcnt lgkmcnt(0)
    v_add_f32 v14, v14, v15
    v_mul_f32 v14, 0x3b124925, v14
    v_sub_f32 v232, 0, v14
    v_mov_b32 v233, v232
    v_mov_b32 v234, 0
    v_mov_b32 v235, 0
    v_pk_add_f32 v[236:237], v[72:73], v[232:233]
    v_pk_fma_f32 v[234:235], v[236:237], v[236:237], v[234:235]
    v_pk_add_f32 v[236:237], v[74:75], v[232:233]
    v_pk_fma_f32 v[234:235], v[236:237], v[236:237], v[234:235]
    v_pk_add_f32 v[236:237], v[76:77], v[232:233]
    v_pk_fma_f32 v[234:235], v[236:237], v[236:237], v[234:235]
    v_pk_add_f32 v[236:237], v[78:79], v[232:233]
    v_pk_fma_f32 v[234:235], v[236:237], v[236:237], v[234:235]
    v_pk_add_f32 v[236:237], v[80:81], v[232:233]
    v_pk_fma_f32 v[234:235], v[236:237], v[236:237], v[234:235]
    v_pk_add_f32 v[236:237], v[82:83], v[232:233]
    v_pk_fma_f32 v[234:235], v[236:237], v[236:237], v[234:235]
    v_pk_add_f32 v[236:237], v[84:85], v[232:233]
    v_pk_fma_f32 v[234:235], v[236:237], v[236:237], v[234:235]
    v_pk_add_f32 v[236:237], v[86:87], v[232:233]
    v_pk_fma_f32 v[234:235], v[236:237], v[236:237], v[234:235]
    v_pk_add_f32 v[236:237], v[88:89], v[232:233]
    v_pk_fma_f32 v[234:235], v[236:237], v[236:237], v[234:235]
    v_pk_add_f32 v[236:237], v[90:91], v[232:233]
    v_pk_fma_f32 v[234:235], v[236:237], v[236:237], v[234:235]
    v_pk_add_f32 v[236:237], v[92:93], v[232:233]
    v_pk_fma_f32 v[234:235], v[236:237], v[236:237], v[234:235]
    v_pk_add_f32 v[236:237], v[94:95], v[232:233]
    v_pk_fma_f32 v[234:235], v[236:237], v[236:237], v[234:235]
    v_pk_add_f32 v[236:237], v[96:97], v[232:233]
    v_pk_fma_f32 v[234:235], v[236:237], v[236:237], v[234:235]
    v_pk_add_f32 v[236:237], v[98:99], v[232:233]
    v_pk_fma_f32 v[234:235], v[236:237], v[236:237], v[234:235]
    v_pk_add_f32 v[236:237], v[100:101], v[232:233]
    v_pk_fma_f32 v[234:235], v[236:237], v[236:237], v[234:235]
    v_pk_add_f32 v[236:237], v[102:103], v[232:233]
    v_pk_fma_f32 v[234:235], v[236:237], v[236:237], v[234:235]
    v_pk_add_f32 v[236:237], v[104:105], v[232:233]
    v_pk_fma_f32 v[234:235], v[236:237], v[236:237], v[234:235]
    v_pk_add_f32 v[236:237], v[106:107], v[232:233]
    v_pk_fma_f32 v[234:235], v[236:237], v[236:237], v[234:235]
    v_pk_add_f32 v[236:237], v[108:109], v[232:233]
    v_pk_fma_f32 v[234:235], v[236:237], v[236:237], v[234:235]
    v_pk_add_f32 v[236:237], v[110:111], v[232:233]
    v_pk_fma_f32 v[234:235], v[236:237], v[236:237], v[234:235]
    v_pk_add_f32 v[236:237], v[112:113], v[232:233]
    v_pk_fma_f32 v[234:235], v[236:237], v[236:237], v[234:235]
    v_pk_add_f32 v[236:237], v[114:115], v[232:233]
    v_pk_fma_f32 v[234:235], v[236:237], v[236:237], v[234:235]
    v_pk_add_f32 v[236:237], v[116:117], v[232:233]
    v_pk_fma_f32 v[234:235], v[236:237], v[236:237], v[234:235]
    v_pk_add_f32 v[236:237], v[118:119], v[232:233]
    v_pk_fma_f32 v[234:235], v[236:237], v[236:237], v[234:235]
    v_pk_add_f32 v[236:237], v[120:121], v[232:233]
    v_pk_fma_f32 v[234:235], v[236:237], v[236:237], v[234:235]
    v_pk_add_f32 v[236:237], v[122:123], v[232:233]
    v_pk_fma_f32 v[234:235], v[236:237], v[236:237], v[234:235]
    v_pk_add_f32 v[236:237], v[124:125], v[232:233]
    v_pk_fma_f32 v[234:235], v[236:237], v[236:237], v[234:235]
    v_pk_add_f32 v[236:237], v[126:127], v[232:233]
    v_pk_fma_f32 v[234:235], v[236:237], v[236:237], v[234:235]
    v_pk_add_f32 v[236:237], v[128:129], v[232:233]
    v_pk_fma_f32 v[234:235], v[236:237], v[236:237], v[234:235]
    v_pk_add_f32 v[236:237], v[130:131], v[232:233]
    v_pk_fma_f32 v[234:235], v[236:237], v[236:237], v[234:235]
    v_pk_add_f32 v[236:237], v[132:133], v[232:233]
    v_pk_fma_f32 v[234:235], v[236:237], v[236:237], v[234:235]
    v_pk_add_f32 v[236:237], v[134:135], v[232:233]
    v_pk_fma_f32 v[234:235], v[236:237], v[236:237], v[234:235]
    v_pk_add_f32 v[236:237], v[136:137], v[232:233]
    v_pk_fma_f32 v[234:235], v[236:237], v[236:237], v[234:235]
    v_pk_add_f32 v[236:237], v[138:139], v[232:233]
    v_pk_fma_f32 v[234:235], v[236:237], v[236:237], v[234:235]
    v_pk_add_f32 v[236:237], v[140:141], v[232:233]
    v_pk_fma_f32 v[234:235], v[236:237], v[236:237], v[234:235]
    v_pk_add_f32 v[236:237], v[142:143], v[232:233]
    v_pk_fma_f32 v[234:235], v[236:237], v[236:237], v[234:235]
    v_pk_add_f32 v[236:237], v[144:145], v[232:233]
    v_pk_fma_f32 v[234:235], v[236:237], v[236:237], v[234:235]
    v_pk_add_f32 v[236:237], v[146:147], v[232:233]
    v_pk_fma_f32 v[234:235], v[236:237], v[236:237], v[234:235]
    v_pk_add_f32 v[236:237], v[148:149], v[232:233]
    v_pk_fma_f32 v[234:235], v[236:237], v[236:237], v[234:235]
    v_pk_add_f32 v[236:237], v[150:151], v[232:233]
    v_pk_fma_f32 v[234:235], v[236:237], v[236:237], v[234:235]
    v_pk_add_f32 v[236:237], v[152:153], v[232:233]
    v_pk_fma_f32 v[234:235], v[236:237], v[236:237], v[234:235]
    v_pk_add_f32 v[236:237], v[154:155], v[232:233]
    v_pk_fma_f32 v[234:235], v[236:237], v[236:237], v[234:235]
    v_pk_add_f32 v[236:237], v[156:157], v[232:233]
    v_pk_fma_f32 v[234:235], v[236:237], v[236:237], v[234:235]
    v_pk_add_f32 v[236:237], v[158:159], v[232:233]
    v_pk_fma_f32 v[234:235], v[236:237], v[236:237], v[234:235]
    v_pk_add_f32 v[236:237], v[160:161], v[232:233]
    v_pk_fma_f32 v[234:235], v[236:237], v[236:237], v[234:235]
    v_pk_add_f32 v[236:237], v[162:163], v[232:233]
    v_pk_fma_f32 v[234:235], v[236:237], v[236:237], v[234:235]
    v_pk_add_f32 v[236:237], v[164:165], v[232:233]
    v_pk_fma_f32 v[234:235], v[236:237], v[236:237], v[234:235]
    v_pk_add_f32 v[236:237], v[166:167], v[232:233]
    v_pk_fma_f32 v[234:235], v[236:237], v[236:237], v[234:235]
    v_pk_add_f32 v[236:237], v[168:169], v[232:233]
    v_pk_fma_f32 v[234:235], v[236:237], v[236:237], v[234:235]
    v_pk_add_f32 v[236:237], v[170:171], v[232:233]
    v_pk_fma_f32 v[234:235], v[236:237], v[236:237], v[234:235]
    v_pk_add_f32 v[236:237], v[172:173], v[232:233]
    v_pk_fma_f32 v[234:235], v[236:237], v[236:237], v[234:235]
    v_pk_add_f32 v[236:237], v[174:175], v[232:233]
    v_pk_fma_f32 v[234:235], v[236:237], v[236:237], v[234:235]
    v_pk_add_f32 v[236:237], v[176:177], v[232:233]
    v_pk_fma_f32 v[234:235], v[236:237], v[236:237], v[234:235]
    v_pk_add_f32 v[236:237], v[178:179], v[232:233]
    v_pk_fma_f32 v[234:235], v[236:237], v[236:237], v[234:235]
    v_pk_add_f32 v[236:237], v[180:181], v[232:233]
    v_pk_fma_f32 v[234:235], v[236:237], v[236:237], v[234:235]
    v_pk_add_f32 v[236:237], v[182:183], v[232:233]
    v_pk_fma_f32 v[234:235], v[236:237], v[236:237], v[234:235]
    v_add_f32 v234, v234, v235
    ds_bpermute_b32 v15, v12, v234
    s_waitcnt lgkmcnt(0)
    v_add_f32 v234, v234, v15
    ds_bpermute_b32 v15, v13, v234
    s_waitcnt lgkmcnt(0)
    v_add_f32 v234, v234, v15
    v_mul_f32 v234, 0x3b124925, v234
    v_cvt_pk_bf16_f32 v14, v14, v14
    v_lshlrev_b32 v14, 16, v14
    v_cvt_pk_bf16_f32 v234, v234, v234
    v_lshlrev_b32 v234, 16, v234
    v_add_f32 v234, 0x3727c5ac, v234
    v_cvt_pk_bf16_f32 v234, v234, v234
    v_lshlrev_b32 v234, 16, v234
    v_sqrt_f32 v234, v234
    s_nop 0
    v_cvt_pk_bf16_f32 v234, v234, v234
    v_lshlrev_b32 v234, 16, v234
    v_rcp_f32 v234, v234
    s_nop 0
    v_mov_b32 v235, v234
    v_sub_f32 v232, 0, v14
    v_mov_b32 v233, v232
    v_pk_add_f32 v[72:73], v[72:73], v[232:233]
    v_cvt_pk_bf16_f32 v16, v72, v73
    v_lshlrev_b32 v72, 16, v16
    v_and_b32 v73, 0xffff0000, v16
    v_pk_mul_f32 v[72:73], v[72:73], v[234:235]
    v_cvt_pk_bf16_f32 v16, v72, v73
    v_pk_add_f32 v[74:75], v[74:75], v[232:233]
    v_cvt_pk_bf16_f32 v17, v74, v75
    v_lshlrev_b32 v74, 16, v17
    v_and_b32 v75, 0xffff0000, v17
    v_pk_mul_f32 v[74:75], v[74:75], v[234:235]
    v_cvt_pk_bf16_f32 v17, v74, v75
    v_pk_add_f32 v[76:77], v[76:77], v[232:233]
    v_cvt_pk_bf16_f32 v18, v76, v77
    v_lshlrev_b32 v76, 16, v18
    v_and_b32 v77, 0xffff0000, v18
    v_pk_mul_f32 v[76:77], v[76:77], v[234:235]
    v_cvt_pk_bf16_f32 v18, v76, v77
    v_pk_add_f32 v[78:79], v[78:79], v[232:233]
    v_cvt_pk_bf16_f32 v19, v78, v79
    v_lshlrev_b32 v78, 16, v19
    v_and_b32 v79, 0xffff0000, v19
    v_pk_mul_f32 v[78:79], v[78:79], v[234:235]
    v_cvt_pk_bf16_f32 v19, v78, v79
    v_pk_add_f32 v[80:81], v[80:81], v[232:233]
    v_cvt_pk_bf16_f32 v20, v80, v81
    v_lshlrev_b32 v80, 16, v20
    v_and_b32 v81, 0xffff0000, v20
    v_pk_mul_f32 v[80:81], v[80:81], v[234:235]
    v_cvt_pk_bf16_f32 v20, v80, v81
    v_pk_add_f32 v[82:83], v[82:83], v[232:233]
    v_cvt_pk_bf16_f32 v21, v82, v83
    v_lshlrev_b32 v82, 16, v21
    v_and_b32 v83, 0xffff0000, v21
    v_pk_mul_f32 v[82:83], v[82:83], v[234:235]
    v_cvt_pk_bf16_f32 v21, v82, v83
    v_pk_add_f32 v[84:85], v[84:85], v[232:233]
    v_cvt_pk_bf16_f32 v22, v84, v85
    v_lshlrev_b32 v84, 16, v22
    v_and_b32 v85, 0xffff0000, v22
    v_pk_mul_f32 v[84:85], v[84:85], v[234:235]
    v_cvt_pk_bf16_f32 v22, v84, v85
    v_pk_add_f32 v[86:87], v[86:87], v[232:233]
    v_cvt_pk_bf16_f32 v23, v86, v87
    v_lshlrev_b32 v86, 16, v23
    v_and_b32 v87, 0xffff0000, v23
    v_pk_mul_f32 v[86:87], v[86:87], v[234:235]
    v_cvt_pk_bf16_f32 v23, v86, v87
    v_pk_add_f32 v[88:89], v[88:89], v[232:233]
    v_cvt_pk_bf16_f32 v24, v88, v89
    v_lshlrev_b32 v88, 16, v24
    v_and_b32 v89, 0xffff0000, v24
    v_pk_mul_f32 v[88:89], v[88:89], v[234:235]
    v_cvt_pk_bf16_f32 v24, v88, v89
    v_pk_add_f32 v[90:91], v[90:91], v[232:233]
    v_cvt_pk_bf16_f32 v25, v90, v91
    v_lshlrev_b32 v90, 16, v25
    v_and_b32 v91, 0xffff0000, v25
    v_pk_mul_f32 v[90:91], v[90:91], v[234:235]
    v_cvt_pk_bf16_f32 v25, v90, v91
    v_pk_add_f32 v[92:93], v[92:93], v[232:233]
    v_cvt_pk_bf16_f32 v26, v92, v93
    v_lshlrev_b32 v92, 16, v26
    v_and_b32 v93, 0xffff0000, v26
    v_pk_mul_f32 v[92:93], v[92:93], v[234:235]
    v_cvt_pk_bf16_f32 v26, v92, v93
    v_pk_add_f32 v[94:95], v[94:95], v[232:233]
    v_cvt_pk_bf16_f32 v27, v94, v95
    v_lshlrev_b32 v94, 16, v27
    v_and_b32 v95, 0xffff0000, v27
    v_pk_mul_f32 v[94:95], v[94:95], v[234:235]
    v_cvt_pk_bf16_f32 v27, v94, v95
    v_pk_add_f32 v[96:97], v[96:97], v[232:233]
    v_cvt_pk_bf16_f32 v28, v96, v97
    v_lshlrev_b32 v96, 16, v28
    v_and_b32 v97, 0xffff0000, v28
    v_pk_mul_f32 v[96:97], v[96:97], v[234:235]
    v_cvt_pk_bf16_f32 v28, v96, v97
    v_pk_add_f32 v[98:99], v[98:99], v[232:233]
    v_cvt_pk_bf16_f32 v29, v98, v99
    v_lshlrev_b32 v98, 16, v29
    v_and_b32 v99, 0xffff0000, v29
    v_pk_mul_f32 v[98:99], v[98:99], v[234:235]
    v_cvt_pk_bf16_f32 v29, v98, v99
    v_pk_add_f32 v[100:101], v[100:101], v[232:233]
    v_cvt_pk_bf16_f32 v30, v100, v101
    v_lshlrev_b32 v100, 16, v30
    v_and_b32 v101, 0xffff0000, v30
    v_pk_mul_f32 v[100:101], v[100:101], v[234:235]
    v_cvt_pk_bf16_f32 v30, v100, v101
    v_pk_add_f32 v[102:103], v[102:103], v[232:233]
    v_cvt_pk_bf16_f32 v31, v102, v103
    v_lshlrev_b32 v102, 16, v31
    v_and_b32 v103, 0xffff0000, v31
    v_pk_mul_f32 v[102:103], v[102:103], v[234:235]
    v_cvt_pk_bf16_f32 v31, v102, v103
    v_pk_add_f32 v[104:105], v[104:105], v[232:233]
    v_cvt_pk_bf16_f32 v32, v104, v105
    v_lshlrev_b32 v104, 16, v32
    v_and_b32 v105, 0xffff0000, v32
    v_pk_mul_f32 v[104:105], v[104:105], v[234:235]
    v_cvt_pk_bf16_f32 v32, v104, v105
    v_pk_add_f32 v[106:107], v[106:107], v[232:233]
    v_cvt_pk_bf16_f32 v33, v106, v107
    v_lshlrev_b32 v106, 16, v33
    v_and_b32 v107, 0xffff0000, v33
    v_pk_mul_f32 v[106:107], v[106:107], v[234:235]
    v_cvt_pk_bf16_f32 v33, v106, v107
    v_pk_add_f32 v[108:109], v[108:109], v[232:233]
    v_cvt_pk_bf16_f32 v34, v108, v109
    v_lshlrev_b32 v108, 16, v34
    v_and_b32 v109, 0xffff0000, v34
    v_pk_mul_f32 v[108:109], v[108:109], v[234:235]
    v_cvt_pk_bf16_f32 v34, v108, v109
    v_pk_add_f32 v[110:111], v[110:111], v[232:233]
    v_cvt_pk_bf16_f32 v35, v110, v111
    v_lshlrev_b32 v110, 16, v35
    v_and_b32 v111, 0xffff0000, v35
    v_pk_mul_f32 v[110:111], v[110:111], v[234:235]
    v_cvt_pk_bf16_f32 v35, v110, v111
    v_pk_add_f32 v[112:113], v[112:113], v[232:233]
    v_cvt_pk_bf16_f32 v36, v112, v113
    v_lshlrev_b32 v112, 16, v36
    v_and_b32 v113, 0xffff0000, v36
    v_pk_mul_f32 v[112:113], v[112:113], v[234:235]
    v_cvt_pk_bf16_f32 v36, v112, v113
    v_pk_add_f32 v[114:115], v[114:115], v[232:233]
    v_cvt_pk_bf16_f32 v37, v114, v115
    v_lshlrev_b32 v114, 16, v37
    v_and_b32 v115, 0xffff0000, v37
    v_pk_mul_f32 v[114:115], v[114:115], v[234:235]
    v_cvt_pk_bf16_f32 v37, v114, v115
    v_pk_add_f32 v[116:117], v[116:117], v[232:233]
    v_cvt_pk_bf16_f32 v38, v116, v117
    v_lshlrev_b32 v116, 16, v38
    v_and_b32 v117, 0xffff0000, v38
    v_pk_mul_f32 v[116:117], v[116:117], v[234:235]
    v_cvt_pk_bf16_f32 v38, v116, v117
    v_pk_add_f32 v[118:119], v[118:119], v[232:233]
    v_cvt_pk_bf16_f32 v39, v118, v119
    v_lshlrev_b32 v118, 16, v39
    v_and_b32 v119, 0xffff0000, v39
    v_pk_mul_f32 v[118:119], v[118:119], v[234:235]
    v_cvt_pk_bf16_f32 v39, v118, v119
    v_pk_add_f32 v[120:121], v[120:121], v[232:233]
    v_cvt_pk_bf16_f32 v40, v120, v121
    v_lshlrev_b32 v120, 16, v40
    v_and_b32 v121, 0xffff0000, v40
    v_pk_mul_f32 v[120:121], v[120:121], v[234:235]
    v_cvt_pk_bf16_f32 v40, v120, v121
    v_pk_add_f32 v[122:123], v[122:123], v[232:233]
    v_cvt_pk_bf16_f32 v41, v122, v123
    v_lshlrev_b32 v122, 16, v41
    v_and_b32 v123, 0xffff0000, v41
    v_pk_mul_f32 v[122:123], v[122:123], v[234:235]
    v_cvt_pk_bf16_f32 v41, v122, v123
    v_pk_add_f32 v[124:125], v[124:125], v[232:233]
    v_cvt_pk_bf16_f32 v42, v124, v125
    v_lshlrev_b32 v124, 16, v42
    v_and_b32 v125, 0xffff0000, v42
    v_pk_mul_f32 v[124:125], v[124:125], v[234:235]
    v_cvt_pk_bf16_f32 v42, v124, v125
    v_pk_add_f32 v[126:127], v[126:127], v[232:233]
    v_cvt_pk_bf16_f32 v43, v126, v127
    v_lshlrev_b32 v126, 16, v43
    v_and_b32 v127, 0xffff0000, v43
    v_pk_mul_f32 v[126:127], v[126:127], v[234:235]
    v_cvt_pk_bf16_f32 v43, v126, v127
    v_pk_add_f32 v[128:129], v[128:129], v[232:233]
    v_cvt_pk_bf16_f32 v44, v128, v129
    v_lshlrev_b32 v128, 16, v44
    v_and_b32 v129, 0xffff0000, v44
    v_pk_mul_f32 v[128:129], v[128:129], v[234:235]
    v_cvt_pk_bf16_f32 v44, v128, v129
    v_pk_add_f32 v[130:131], v[130:131], v[232:233]
    v_cvt_pk_bf16_f32 v45, v130, v131
    v_lshlrev_b32 v130, 16, v45
    v_and_b32 v131, 0xffff0000, v45
    v_pk_mul_f32 v[130:131], v[130:131], v[234:235]
    v_cvt_pk_bf16_f32 v45, v130, v131
    v_pk_add_f32 v[132:133], v[132:133], v[232:233]
    v_cvt_pk_bf16_f32 v46, v132, v133
    v_lshlrev_b32 v132, 16, v46
    v_and_b32 v133, 0xffff0000, v46
    v_pk_mul_f32 v[132:133], v[132:133], v[234:235]
    v_cvt_pk_bf16_f32 v46, v132, v133
    v_pk_add_f32 v[134:135], v[134:135], v[232:233]
    v_cvt_pk_bf16_f32 v47, v134, v135
    v_lshlrev_b32 v134, 16, v47
    v_and_b32 v135, 0xffff0000, v47
    v_pk_mul_f32 v[134:135], v[134:135], v[234:235]
    v_cvt_pk_bf16_f32 v47, v134, v135
    v_pk_add_f32 v[136:137], v[136:137], v[232:233]
    v_cvt_pk_bf16_f32 v48, v136, v137
    v_lshlrev_b32 v136, 16, v48
    v_and_b32 v137, 0xffff0000, v48
    v_pk_mul_f32 v[136:137], v[136:137], v[234:235]
    v_cvt_pk_bf16_f32 v48, v136, v137
    v_pk_add_f32 v[138:139], v[138:139], v[232:233]
    v_cvt_pk_bf16_f32 v49, v138, v139
    v_lshlrev_b32 v138, 16, v49
    v_and_b32 v139, 0xffff0000, v49
    v_pk_mul_f32 v[138:139], v[138:139], v[234:235]
    v_cvt_pk_bf16_f32 v49, v138, v139
    v_pk_add_f32 v[140:141], v[140:141], v[232:233]
    v_cvt_pk_bf16_f32 v50, v140, v141
    v_lshlrev_b32 v140, 16, v50
    v_and_b32 v141, 0xffff0000, v50
    v_pk_mul_f32 v[140:141], v[140:141], v[234:235]
    v_cvt_pk_bf16_f32 v50, v140, v141
    v_pk_add_f32 v[142:143], v[142:143], v[232:233]
    v_cvt_pk_bf16_f32 v51, v142, v143
    v_lshlrev_b32 v142, 16, v51
    v_and_b32 v143, 0xffff0000, v51
    v_pk_mul_f32 v[142:143], v[142:143], v[234:235]
    v_cvt_pk_bf16_f32 v51, v142, v143
    v_pk_add_f32 v[144:145], v[144:145], v[232:233]
    v_cvt_pk_bf16_f32 v52, v144, v145
    v_lshlrev_b32 v144, 16, v52
    v_and_b32 v145, 0xffff0000, v52
    v_pk_mul_f32 v[144:145], v[144:145], v[234:235]
    v_cvt_pk_bf16_f32 v52, v144, v145
    v_pk_add_f32 v[146:147], v[146:147], v[232:233]
    v_cvt_pk_bf16_f32 v53, v146, v147
    v_lshlrev_b32 v146, 16, v53
    v_and_b32 v147, 0xffff0000, v53
    v_pk_mul_f32 v[146:147], v[146:147], v[234:235]
    v_cvt_pk_bf16_f32 v53, v146, v147
    v_pk_add_f32 v[148:149], v[148:149], v[232:233]
    v_cvt_pk_bf16_f32 v54, v148, v149
    v_lshlrev_b32 v148, 16, v54
    v_and_b32 v149, 0xffff0000, v54
    v_pk_mul_f32 v[148:149], v[148:149], v[234:235]
    v_cvt_pk_bf16_f32 v54, v148, v149
    v_pk_add_f32 v[150:151], v[150:151], v[232:233]
    v_cvt_pk_bf16_f32 v55, v150, v151
    v_lshlrev_b32 v150, 16, v55
    v_and_b32 v151, 0xffff0000, v55
    v_pk_mul_f32 v[150:151], v[150:151], v[234:235]
    v_cvt_pk_bf16_f32 v55, v150, v151
    v_pk_add_f32 v[152:153], v[152:153], v[232:233]
    v_cvt_pk_bf16_f32 v56, v152, v153
    v_lshlrev_b32 v152, 16, v56
    v_and_b32 v153, 0xffff0000, v56
    v_pk_mul_f32 v[152:153], v[152:153], v[234:235]
    v_cvt_pk_bf16_f32 v56, v152, v153
    v_pk_add_f32 v[154:155], v[154:155], v[232:233]
    v_cvt_pk_bf16_f32 v57, v154, v155
    v_lshlrev_b32 v154, 16, v57
    v_and_b32 v155, 0xffff0000, v57
    v_pk_mul_f32 v[154:155], v[154:155], v[234:235]
    v_cvt_pk_bf16_f32 v57, v154, v155
    v_pk_add_f32 v[156:157], v[156:157], v[232:233]
    v_cvt_pk_bf16_f32 v58, v156, v157
    v_lshlrev_b32 v156, 16, v58
    v_and_b32 v157, 0xffff0000, v58
    v_pk_mul_f32 v[156:157], v[156:157], v[234:235]
    v_cvt_pk_bf16_f32 v58, v156, v157
    v_pk_add_f32 v[158:159], v[158:159], v[232:233]
    v_cvt_pk_bf16_f32 v59, v158, v159
    v_lshlrev_b32 v158, 16, v59
    v_and_b32 v159, 0xffff0000, v59
    v_pk_mul_f32 v[158:159], v[158:159], v[234:235]
    v_cvt_pk_bf16_f32 v59, v158, v159
    v_pk_add_f32 v[160:161], v[160:161], v[232:233]
    v_cvt_pk_bf16_f32 v60, v160, v161
    v_lshlrev_b32 v160, 16, v60
    v_and_b32 v161, 0xffff0000, v60
    v_pk_mul_f32 v[160:161], v[160:161], v[234:235]
    v_cvt_pk_bf16_f32 v60, v160, v161
    v_pk_add_f32 v[162:163], v[162:163], v[232:233]
    v_cvt_pk_bf16_f32 v61, v162, v163
    v_lshlrev_b32 v162, 16, v61
    v_and_b32 v163, 0xffff0000, v61
    v_pk_mul_f32 v[162:163], v[162:163], v[234:235]
    v_cvt_pk_bf16_f32 v61, v162, v163
    v_pk_add_f32 v[164:165], v[164:165], v[232:233]
    v_cvt_pk_bf16_f32 v62, v164, v165
    v_lshlrev_b32 v164, 16, v62
    v_and_b32 v165, 0xffff0000, v62
    v_pk_mul_f32 v[164:165], v[164:165], v[234:235]
    v_cvt_pk_bf16_f32 v62, v164, v165
    v_pk_add_f32 v[166:167], v[166:167], v[232:233]
    v_cvt_pk_bf16_f32 v63, v166, v167
    v_lshlrev_b32 v166, 16, v63
    v_and_b32 v167, 0xffff0000, v63
    v_pk_mul_f32 v[166:167], v[166:167], v[234:235]
    v_cvt_pk_bf16_f32 v63, v166, v167
    v_pk_add_f32 v[168:169], v[168:169], v[232:233]
    v_cvt_pk_bf16_f32 v64, v168, v169
    v_lshlrev_b32 v168, 16, v64
    v_and_b32 v169, 0xffff0000, v64
    v_pk_mul_f32 v[168:169], v[168:169], v[234:235]
    v_cvt_pk_bf16_f32 v64, v168, v169
    v_pk_add_f32 v[170:171], v[170:171], v[232:233]
    v_cvt_pk_bf16_f32 v65, v170, v171
    v_lshlrev_b32 v170, 16, v65
    v_and_b32 v171, 0xffff0000, v65
    v_pk_mul_f32 v[170:171], v[170:171], v[234:235]
    v_cvt_pk_bf16_f32 v65, v170, v171
    v_pk_add_f32 v[172:173], v[172:173], v[232:233]
    v_cvt_pk_bf16_f32 v66, v172, v173
    v_lshlrev_b32 v172, 16, v66
    v_and_b32 v173, 0xffff0000, v66
    v_pk_mul_f32 v[172:173], v[172:173], v[234:235]
    v_cvt_pk_bf16_f32 v66, v172, v173
    v_pk_add_f32 v[174:175], v[174:175], v[232:233]
    v_cvt_pk_bf16_f32 v67, v174, v175
    v_lshlrev_b32 v174, 16, v67
    v_and_b32 v175, 0xffff0000, v67
    v_pk_mul_f32 v[174:175], v[174:175], v[234:235]
    v_cvt_pk_bf16_f32 v67, v174, v175
    v_pk_add_f32 v[176:177], v[176:177], v[232:233]
    v_cvt_pk_bf16_f32 v68, v176, v177
    v_lshlrev_b32 v176, 16, v68
    v_and_b32 v177, 0xffff0000, v68
    v_pk_mul_f32 v[176:177], v[176:177], v[234:235]
    v_cvt_pk_bf16_f32 v68, v176, v177
    v_pk_add_f32 v[178:179], v[178:179], v[232:233]
    v_cvt_pk_bf16_f32 v69, v178, v179
    v_lshlrev_b32 v178, 16, v69
    v_and_b32 v179, 0xffff0000, v69
    v_pk_mul_f32 v[178:179], v[178:179], v[234:235]
    v_cvt_pk_bf16_f32 v69, v178, v179
    v_pk_add_f32 v[180:181], v[180:181], v[232:233]
    v_cvt_pk_bf16_f32 v70, v180, v181
    v_lshlrev_b32 v180, 16, v70
    v_and_b32 v181, 0xffff0000, v70
    v_pk_mul_f32 v[180:181], v[180:181], v[234:235]
    v_cvt_pk_bf16_f32 v70, v180, v181
    v_pk_add_f32 v[182:183], v[182:183], v[232:233]
    v_cvt_pk_bf16_f32 v71, v182, v183
    v_lshlrev_b32 v182, 16, v71
    v_and_b32 v183, 0xffff0000, v71
    v_pk_mul_f32 v[182:183], v[182:183], v[234:235]
    v_cvt_pk_bf16_f32 v71, v182, v183
    s_lshl_b32 s35, s28, 8
    s_add_u32 s35, s35, 79872
    v_lshlrev_b32 v15, 4, v2
    v_add_u32 v15, s35, v15
    v_and_b32 v236, 1, v3
    v_lshl_add_u32 v15, v236, 11, v15
    v_lshrrev_b32 v236, 1, v3
    v_lshl_add_u32 v15, v236, 3, v15
    ds_write2st64_b64 v15, v[16:17], v[18:19] offset0:0 offset1:2
    ds_write2st64_b64 v15, v[20:21], v[22:23] offset0:8 offset1:10
    ds_write2st64_b64 v15, v[24:25], v[26:27] offset0:16 offset1:18
    ds_write2st64_b64 v15, v[28:29], v[30:31] offset0:24 offset1:26
    ds_write2st64_b64 v15, v[32:33], v[34:35] offset0:32 offset1:34
    ds_write2st64_b64 v15, v[36:37], v[38:39] offset0:40 offset1:42
    ds_write2st64_b64 v15, v[40:41], v[42:43] offset0:48 offset1:50
    ds_write2st64_b64 v15, v[44:45], v[46:47] offset0:56 offset1:58
    ds_write2st64_b64 v15, v[48:49], v[50:51] offset0:64 offset1:66
    ds_write2st64_b64 v15, v[52:53], v[54:55] offset0:72 offset1:74
    ds_write2st64_b64 v15, v[56:57], v[58:59] offset0:80 offset1:82
    ds_write2st64_b64 v15, v[60:61], v[62:63] offset0:88 offset1:90
    ds_write2st64_b64 v15, v[64:65], v[66:67] offset0:96 offset1:98
    ds_write2st64_b64 v15, v[68:69], v[70:71] offset0:104 offset1:106
    s_waitcnt vmcnt(11)
    ds_write_b128 v11, v[184:187] offset:0
    s_waitcnt vmcnt(10)
    ds_write_b128 v11, v[188:191] offset:128
    s_waitcnt vmcnt(9)
    ds_write_b128 v11, v[192:195] offset:256
    s_waitcnt vmcnt(8)
    ds_write_b128 v11, v[196:199] offset:13312
    s_waitcnt vmcnt(7)
    ds_write_b128 v11, v[200:203] offset:13440
    s_waitcnt vmcnt(6)
    ds_write_b128 v11, v[204:207] offset:13568
    s_add_u32 s34, s33, 344064
    buffer_load_dwordx4 v[184:187], v9, s[16:19], s34 offen offset:0
    buffer_load_dwordx4 v[188:191], v9, s[16:19], s34 offen offset:128
    buffer_load_dwordx4 v[192:195], v9, s[16:19], s34 offen offset:256
    buffer_load_dwordx4 v[196:199], v10, s[16:19], s34 offen offset:0
    buffer_load_dwordx4 v[200:203], v10, s[16:19], s34 offen offset:128
    buffer_load_dwordx4 v[204:207], v10, s[16:19], s34 offen offset:256
    s_waitcnt vmcnt(11)
    ds_write_b128 v11, v[208:211] offset:26624
    s_waitcnt vmcnt(10)
    ds_write_b128 v11, v[212:215] offset:26752
    s_waitcnt vmcnt(9)
    ds_write_b128 v11, v[216:219] offset:26880
    s_waitcnt vmcnt(8)
    ds_write_b128 v11, v[220:223] offset:39936
    s_waitcnt vmcnt(7)
    ds_write_b128 v11, v[224:227] offset:40064
    s_waitcnt vmcnt(6)
    ds_write_b128 v11, v[228:231] offset:40192
    s_add_u32 s34, s33, 516096
    buffer_load_dwordx4 v[208:211], v9, s[16:19], s34 offen offset:0
    buffer_load_dwordx4 v[212:215], v9, s[16:19], s34 offen offset:128
    buffer_load_dwordx4 v[216:219], v9, s[16:19], s34 offen offset:256
    buffer_load_dwordx4 v[220:223], v10, s[16:19], s34 offen offset:0
    buffer_load_dwordx4 v[224:227], v10, s[16:19], s34 offen offset:128
    buffer_load_dwordx4 v[228:231], v10, s[16:19], s34 offen offset:256
    s_cmp_lg_u32 s2, 0
    s_waitcnt vmcnt(0) lgkmcnt(0)
    s_cbranch_scc1 k1_skip_r
    v_lshlrev_b32 v236, 4, v3
    buffer_load_dwordx4 v[120:123], v236, s[24:27], 0 offen offset:0
    buffer_load_dwordx4 v[124:127], v236, s[24:27], 0 offen offset:64
    buffer_load_dwordx4 v[128:131], v236, s[24:27], 0 offen offset:128
    buffer_load_dwordx4 v[132:135], v236, s[24:27], 0 offen offset:192
    buffer_load_dwordx4 v[136:139], v236, s[24:27], 0 offen offset:256
    buffer_load_dwordx4 v[140:143], v236, s[24:27], 0 offen offset:320
    buffer_load_dwordx4 v[144:147], v236, s[24:27], 0 offen offset:384
    buffer_load_dwordx4 v[148:151], v236, s[24:27], 0 offen offset:448
    buffer_load_dwordx4 v[152:155], v236, s[24:27], 0 offen offset:512
    buffer_load_dwordx4 v[156:159], v236, s[24:27], 0 offen offset:576
    buffer_load_dwordx4 v[160:163], v236, s[24:27], 0 offen offset:640
    buffer_load_dwordx4 v[164:167], v236, s[24:27], 0 offen offset:704
    buffer_load_dwordx4 v[168:171], v236, s[24:27], 0 offen offset:768
    buffer_load_dwordx4 v[172:175], v236, s[24:27], 0 offen offset:832
    v_mov_b32 v237, 0
    s_waitcnt vmcnt(13)
    v_dot2_f32_bf16 v237, v16, v120, v237
    v_dot2_f32_bf16 v237, v17, v121, v237
    v_dot2_f32_bf16 v237, v18, v122, v237
    v_dot2_f32_bf16 v237, v19, v123, v237
    s_waitcnt vmcnt(12)
    v_dot2_f32_bf16 v237, v20, v124, v237
    v_dot2_f32_bf16 v237, v21, v125, v237
    v_dot2_f32_bf16 v237, v22, v126, v237
    v_dot2_f32_bf16 v237, v23, v127, v237
    s_waitcnt vmcnt(11)
    v_dot2_f32_bf16 v237, v24, v128, v237
    v_dot2_f32_bf16 v237, v25, v129, v237
    v_dot2_f32_bf16 v237, v26, v130, v237
    v_dot2_f32_bf16 v237, v27, v131, v237
    s_waitcnt vmcnt(10)
    v_dot2_f32_bf16 v237, v28, v132, v237
    v_dot2_f32_bf16 v237, v29, v133, v237
    v_dot2_f32_bf16 v237, v30, v134, v237
    v_dot2_f32_bf16 v237, v31, v135, v237
    s_waitcnt vmcnt(9)
    v_dot2_f32_bf16 v237, v32, v136, v237
    v_dot2_f32_bf16 v237, v33, v137, v237
    v_dot2_f32_bf16 v237, v34, v138, v237
    v_dot2_f32_bf16 v237, v35, v139, v237
    s_waitcnt vmcnt(8)
    v_dot2_f32_bf16 v237, v36, v140, v237
    v_dot2_f32_bf16 v237, v37, v141, v237
    v_dot2_f32_bf16 v237, v38, v142, v237
    v_dot2_f32_bf16 v237, v39, v143, v237
    s_waitcnt vmcnt(7)
    v_dot2_f32_bf16 v237, v40, v144, v237
    v_dot2_f32_bf16 v237, v41, v145, v237
    v_dot2_f32_bf16 v237, v42, v146, v237
    v_dot2_f32_bf16 v237, v43, v147, v237
    s_waitcnt vmcnt(6)
    v_dot2_f32_bf16 v237, v44, v148, v237
    v_dot2_f32_bf16 v237, v45, v149, v237
    v_dot2_f32_bf16 v237, v46, v150, v237
    v_dot2_f32_bf16 v237, v47, v151, v237
    s_waitcnt vmcnt(5)
    v_dot2_f32_bf16 v237, v48, v152, v237
    v_dot2_f32_bf16 v237, v49, v153, v237
    v_dot2_f32_bf16 v237, v50, v154, v237
    v_dot2_f32_bf16 v237, v51, v155, v237
    s_waitcnt vmcnt(4)
    v_dot2_f32_bf16 v237, v52, v156, v237
    v_dot2_f32_bf16 v237, v53, v157, v237
    v_dot2_f32_bf16 v237, v54, v158, v237
    v_dot2_f32_bf16 v237, v55, v159, v237
    s_waitcnt vmcnt(3)
    v_dot2_f32_bf16 v237, v56, v160, v237
    v_dot2_f32_bf16 v237, v57, v161, v237
    v_dot2_f32_bf16 v237, v58, v162, v237
    v_dot2_f32_bf16 v237, v59, v163, v237
    s_waitcnt vmcnt(2)
    v_dot2_f32_bf16 v237, v60, v164, v237
    v_dot2_f32_bf16 v237, v61, v165, v237
    v_dot2_f32_bf16 v237, v62, v166, v237
    v_dot2_f32_bf16 v237, v63, v167, v237
    s_waitcnt vmcnt(1)
    v_dot2_f32_bf16 v237, v64, v168, v237
    v_dot2_f32_bf16 v237, v65, v169, v237
    v_dot2_f32_bf16 v237, v66, v170, v237
    v_dot2_f32_bf16 v237, v67, v171, v237
    s_waitcnt vmcnt(0)
    v_dot2_f32_bf16 v237, v68, v172, v237
    v_dot2_f32_bf16 v237, v69, v173, v237
    v_dot2_f32_bf16 v237, v70, v174, v237
    v_dot2_f32_bf16 v237, v71, v175, v237
    ds_bpermute_b32 v238, v12, v237
    s_waitcnt lgkmcnt(0)
    v_add_f32 v237, v237, v238
    ds_bpermute_b32 v238, v13, v237
    s_waitcnt lgkmcnt(0)
    v_add_f32 v237, v237, v238
    v_cvt_pk_bf16_f32 v237, v237, v237
    v_lshlrev_b32 v237, 16, v237
    v_cmp_gt_u32 vcc, 16, v1
    s_and_saveexec_b64 s[40:41], vcc
    v_lshlrev_b32 v238, 2, v6
    v_add_u32 v238, 0x544000, v238
    buffer_store_dword v237, v238, s[20:23], 0 offen
    v_lshlrev_b32 v238, 3, v6
    v_add_u32 v238, 0x540000, v238
    v_mov_b32 v236, v14
    v_mov_b32 v237, v234
    buffer_store_dwordx2 v[236:237], v238, s[20:23], 0 offen
    s_mov_b64 exec, s[40:41]
    s_waitcnt vmcnt(0)
k1_skip_r:
    v_lshlrev_b32 v4, 4, v2
    v_lshl_add_u32 v4, v3, 10, v4
    v_add_u32 v4, 79872, v4
    v_bfe_u32 v5, v0, 2, 4
    v_mul_u32_u24 v5, 416, v5
    v_and_b32 v7, 3, v0
    v_lshl_add_u32 v5, v7, 3, v5
    s_mul_i32 s35, s28, 96
    v_add_u32 v5, s35, v5
    v_add_u32 v6, 53248, v5
    v_add_u32 v7, 53248, v11
    v_mov_b32 v72, 0
    v_mov_b32 v73, 0
    v_mov_b32 v74, 0
    v_mov_b32 v75, 0
    v_mov_b32 v76, 0
    v_mov_b32 v77, 0
    v_mov_b32 v78, 0
    v_mov_b32 v79, 0
    v_mov_b32 v80, 0
    v_mov_b32 v81, 0
    v_mov_b32 v82, 0
    v_mov_b32 v83, 0
    v_mov_b32 v84, 0
    v_mov_b32 v85, 0
    v_mov_b32 v86, 0
    v_mov_b32 v87, 0
    v_mov_b32 v88, 0
    v_mov_b32 v89, 0
    v_mov_b32 v90, 0
    v_mov_b32 v91, 0
    v_mov_b32 v92, 0
    v_mov_b32 v93, 0
    v_mov_b32 v94, 0
    v_mov_b32 v95, 0
    v_mov_b32 v96, 0
    v_mov_b32 v97, 0
    v_mov_b32 v98, 0
    v_mov_b32 v99, 0
    v_mov_b32 v100, 0
    v_mov_b32 v101, 0
    v_mov_b32 v102, 0
    v_mov_b32 v103, 0
    v_mov_b32 v104, 0
    v_mov_b32 v105, 0
    v_mov_b32 v106, 0
    v_mov_b32 v107, 0
    v_mov_b32 v108, 0
    v_mov_b32 v109, 0
    v_mov_b32 v110, 0
    v_mov_b32 v111, 0
    v_mov_b32 v112, 0
    v_mov_b32 v113, 0
    v_mov_b32 v114, 0
    v_mov_b32 v115, 0
    v_mov_b32 v116, 0
    v_mov_b32 v117, 0
    v_mov_b32 v118, 0
    v_mov_b32 v119, 0
    s_waitcnt lgkmcnt(0)
    s_barrier
    ds_read_b128 v[120:123], v4 offset:0
    ds_read_b128 v[124:127], v4 offset:256
    ds_read_b128 v[128:131], v4 offset:512
    ds_read_b128 v[132:135], v4 offset:768
    ds_read_b64_tr_b16 v[152:153], v5 offset:0
    ds_read_b64_tr_b16 v[154:155], v5 offset:6656
    ds_read_b64_tr_b16 v[156:157], v5 offset:32
    ds_read_b64_tr_b16 v[158:159], v5 offset:6688
    ds_read_b64_tr_b16 v[160:161], v5 offset:64
    ds_read_b64_tr_b16 v[162:163], v5 offset:6720
    ds_read_b128 v[136:139], v4 offset:4096
    ds_read_b128 v[140:143], v4 offset:4352
    ds_read_b128 v[144:147], v4 offset:4608
    ds_read_b128 v[148:151], v4 offset:4864
    ds_read_b64_tr_b16 v[164:165], v5 offset:13312
    ds_read_b64_tr_b16 v[166:167], v5 offset:19968
    ds_read_b64_tr_b16 v[168:169], v5 offset:13344
    ds_read_b64_tr_b16 v[170:171], v5 offset:20000
    ds_read_b64_tr_b16 v[172:173], v5 offset:13376
    ds_read_b64_tr_b16 v[174:175], v5 offset:20032
    s_waitcnt lgkmcnt(14)
    v_mfma_f32_16x16x32_bf16 v[72:75], v[152:155], v[120:123], v[72:75]
    s_waitcnt lgkmcnt(12)
    v_mfma_f32_16x16x32_bf16 v[76:79], v[156:159], v[120:123], v[76:79]
    s_waitcnt lgkmcnt(10)
    v_mfma_f32_16x16x32_bf16 v[80:83], v[160:163], v[120:123], v[80:83]
    v_mfma_f32_16x16x32_bf16 v[84:87], v[152:155], v[124:127], v[84:87]
    v_mfma_f32_16x16x32_bf16 v[88:91], v[156:159], v[124:127], v[88:91]
    v_mfma_f32_16x16x32_bf16 v[92:95], v[160:163], v[124:127], v[92:95]
    v_mfma_f32_16x16x32_bf16 v[96:99], v[152:155], v[128:131], v[96:99]
    v_mfma_f32_16x16x32_bf16 v[100:103], v[156:159], v[128:131], v[100:103]
    v_mfma_f32_16x16x32_bf16 v[104:107], v[160:163], v[128:131], v[104:107]
    v_mfma_f32_16x16x32_bf16 v[108:111], v[152:155], v[132:135], v[108:111]
    v_mfma_f32_16x16x32_bf16 v[112:115], v[156:159], v[132:135], v[112:115]
    v_mfma_f32_16x16x32_bf16 v[116:119], v[160:163], v[132:135], v[116:119]
    ds_write_b128 v7, v[184:187] offset:0
    ds_write_b128 v7, v[188:191] offset:128
    ds_write_b128 v7, v[192:195] offset:256
    ds_write_b128 v7, v[196:199] offset:13312
    ds_write_b128 v7, v[200:203] offset:13440
    ds_write_b128 v7, v[204:207] offset:13568
    s_add_u32 s34, s33, 688128
    buffer_load_dwordx4 v[184:187], v9, s[16:19], s34 offen offset:0
    buffer_load_dwordx4 v[188:191], v9, s[16:19], s34 offen offset:128
    buffer_load_dwordx4 v[192:195], v9, s[16:19], s34 offen offset:256
    buffer_load_dwordx4 v[196:199], v10, s[16:19], s34 offen offset:0
    buffer_load_dwordx4 v[200:203], v10, s[16:19], s34 offen offset:128
    buffer_load_dwordx4 v[204:207], v10, s[16:19], s34 offen offset:256
    ds_read_b128 v[120:123], v4 offset:8192
    ds_read_b128 v[124:127], v4 offset:8448
    ds_read_b128 v[128:131], v4 offset:8704
    ds_read_b128 v[132:135], v4 offset:8960
    ds_read_b64_tr_b16 v[152:153], v5 offset:26624
    ds_read_b64_tr_b16 v[154:155], v5 offset:33280
    ds_read_b64_tr_b16 v[156:157], v5 offset:26656
    ds_read_b64_tr_b16 v[158:159], v5 offset:33312
    ds_read_b64_tr_b16 v[160:161], v5 offset:26688
    ds_read_b64_tr_b16 v[162:163], v5 offset:33344
    s_waitcnt lgkmcnt(15)
    v_mfma_f32_16x16x32_bf16 v[72:75], v[164:167], v[136:139], v[72:75]
    v_mfma_f32_16x16x32_bf16 v[76:79], v[168:171], v[136:139], v[76:79]
    v_mfma_f32_16x16x32_bf16 v[80:83], v[172:175], v[136:139], v[80:83]
    v_mfma_f32_16x16x32_bf16 v[84:87], v[164:167], v[140:143], v[84:87]
    v_mfma_f32_16x16x32_bf16 v[88:91], v[168:171], v[140:143], v[88:91]
    v_mfma_f32_16x16x32_bf16 v[92:95], v[172:175], v[140:143], v[92:95]
    v_mfma_f32_16x16x32_bf16 v[96:99], v[164:167], v[144:147], v[96:99]
    v_mfma_f32_16x16x32_bf16 v[100:103], v[168:171], v[144:147], v[100:103]
    v_mfma_f32_16x16x32_bf16 v[104:107], v[172:175], v[144:147], v[104:107]
    v_mfma_f32_16x16x32_bf16 v[108:111], v[164:167], v[148:151], v[108:111]
    v_mfma_f32_16x16x32_bf16 v[112:115], v[168:171], v[148:151], v[112:115]
    v_mfma_f32_16x16x32_bf16 v[116:119], v[172:175], v[148:151], v[116:119]
    s_waitcnt lgkmcnt(0)
    s_barrier
    ds_read_b128 v[136:139], v4 offset:12288
    ds_read_b128 v[140:143], v4 offset:12544
    ds_read_b128 v[144:147], v4 offset:12800
    ds_read_b128 v[148:151], v4 offset:13056
    ds_read_b64_tr_b16 v[164:165], v5 offset:39936
    ds_read_b64_tr_b16 v[166:167], v5 offset:46592
    ds_read_b64_tr_b16 v[168:169], v5 offset:39968
    ds_read_b64_tr_b16 v[170:171], v5 offset:46624
    ds_read_b64_tr_b16 v[172:173], v5 offset:40000
    ds_read_b64_tr_b16 v[174:175], v5 offset:46656
    v_mfma_f32_16x16x32_bf16 v[72:75], v[152:155], v[120:123], v[72:75]
    v_mfma_f32_16x16x32_bf16 v[76:79], v[156:159], v[120:123], v[76:79]
    v_mfma_f32_16x16x32_bf16 v[80:83], v[160:163], v[120:123], v[80:83]
    v_mfma_f32_16x16x32_bf16 v[84:87], v[152:155], v[124:127], v[84:87]
    v_mfma_f32_16x16x32_bf16 v[88:91], v[156:159], v[124:127], v[88:91]
    v_mfma_f32_16x16x32_bf16 v[92:95], v[160:163], v[124:127], v[92:95]
    v_mfma_f32_16x16x32_bf16 v[96:99], v[152:155], v[128:131], v[96:99]
    v_mfma_f32_16x16x32_bf16 v[100:103], v[156:159], v[128:131], v[100:103]
    v_mfma_f32_16x16x32_bf16 v[104:107], v[160:163], v[128:131], v[104:107]
    v_mfma_f32_16x16x32_bf16 v[108:111], v[152:155], v[132:135], v[108:111]
    v_mfma_f32_16x16x32_bf16 v[112:115], v[156:159], v[132:135], v[112:115]
    v_mfma_f32_16x16x32_bf16 v[116:119], v[160:163], v[132:135], v[116:119]
    ds_write_b128 v11, v[208:211] offset:0
    ds_write_b128 v11, v[212:215] offset:128
    ds_write_b128 v11, v[216:219] offset:256
    ds_write_b128 v11, v[220:223] offset:13312
    ds_write_b128 v11, v[224:227] offset:13440
    ds_write_b128 v11, v[228:231] offset:13568
    s_add_u32 s34, s33, 860160
    buffer_load_dwordx4 v[208:211], v9, s[16:19], s34 offen offset:0
    buffer_load_dwordx4 v[212:215], v9, s[16:19], s34 offen offset:128
    buffer_load_dwordx4 v[216:219], v9, s[16:19], s34 offen offset:256
    buffer_load_dwordx4 v[220:223], v10, s[16:19], s34 offen offset:0
    buffer_load_dwordx4 v[224:227], v10, s[16:19], s34 offen offset:128
    buffer_load_dwordx4 v[228:231], v10, s[16:19], s34 offen offset:256
    ds_read_b128 v[120:123], v4 offset:16384
    ds_read_b128 v[124:127], v4 offset:16640
    ds_read_b128 v[128:131], v4 offset:16896
    ds_read_b128 v[132:135], v4 offset:17152
    ds_read_b64_tr_b16 v[152:153], v6 offset:0
    ds_read_b64_tr_b16 v[154:155], v6 offset:6656
    ds_read_b64_tr_b16 v[156:157], v6 offset:32
    ds_read_b64_tr_b16 v[158:159], v6 offset:6688
    ds_read_b64_tr_b16 v[160:161], v6 offset:64
    ds_read_b64_tr_b16 v[162:163], v6 offset:6720
    s_waitcnt lgkmcnt(15)
    v_mfma_f32_16x16x32_bf16 v[72:75], v[164:167], v[136:139], v[72:75]
    v_mfma_f32_16x16x32_bf16 v[76:79], v[168:171], v[136:139], v[76:79]
    v_mfma_f32_16x16x32_bf16 v[80:83], v[172:175], v[136:139], v[80:83]
    v_mfma_f32_16x16x32_bf16 v[84:87], v[164:167], v[140:143], v[84:87]
    v_mfma_f32_16x16x32_bf16 v[88:91], v[168:171], v[140:143], v[88:91]
    v_mfma_f32_16x16x32_bf16 v[92:95], v[172:175], v[140:143], v[92:95]
    v_mfma_f32_16x16x32_bf16 v[96:99], v[164:167], v[144:147], v[96:99]
    v_mfma_f32_16x16x32_bf16 v[100:103], v[168:171], v[144:147], v[100:103]
    v_mfma_f32_16x16x32_bf16 v[104:107], v[172:175], v[144:147], v[104:107]
    v_mfma_f32_16x16x32_bf16 v[108:111], v[164:167], v[148:151], v[108:111]
    v_mfma_f32_16x16x32_bf16 v[112:115], v[168:171], v[148:151], v[112:115]
    v_mfma_f32_16x16x32_bf16 v[116:119], v[172:175], v[148:151], v[116:119]
    s_waitcnt lgkmcnt(0)
    s_barrier
    ds_read_b128 v[136:139], v4 offset:20480
    ds_read_b128 v[140:143], v4 offset:20736
    ds_read_b128 v[144:147], v4 offset:20992
    ds_read_b128 v[148:151], v4 offset:21248
    ds_read_b64_tr_b16 v[164:165], v6 offset:13312
    ds_read_b64_tr_b16 v[166:167], v6 offset:19968
    ds_read_b64_tr_b16 v[168:169], v6 offset:13344
    ds_read_b64_tr_b16 v[170:171], v6 offset:20000
    ds_read_b64_tr_b16 v[172:173], v6 offset:13376
    ds_read_b64_tr_b16 v[174:175], v6 offset:20032
    v_mfma_f32_16x16x32_bf16 v[72:75], v[152:155], v[120:123], v[72:75]
    v_mfma_f32_16x16x32_bf16 v[76:79], v[156:159], v[120:123], v[76:79]
    v_mfma_f32_16x16x32_bf16 v[80:83], v[160:163], v[120:123], v[80:83]
    v_mfma_f32_16x16x32_bf16 v[84:87], v[152:155], v[124:127], v[84:87]
    v_mfma_f32_16x16x32_bf16 v[88:91], v[156:159], v[124:127], v[88:91]
    v_mfma_f32_16x16x32_bf16 v[92:95], v[160:163], v[124:127], v[92:95]
    v_mfma_f32_16x16x32_bf16 v[96:99], v[152:155], v[128:131], v[96:99]
    v_mfma_f32_16x16x32_bf16 v[100:103], v[156:159], v[128:131], v[100:103]
    v_mfma_f32_16x16x32_bf16 v[104:107], v[160:163], v[128:131], v[104:107]
    v_mfma_f32_16x16x32_bf16 v[108:111], v[152:155], v[132:135], v[108:111]
    v_mfma_f32_16x16x32_bf16 v[112:115], v[156:159], v[132:135], v[112:115]
    v_mfma_f32_16x16x32_bf16 v[116:119], v[160:163], v[132:135], v[116:119]
    s_waitcnt vmcnt(11)
    ds_write_b128 v11, v[184:187] offset:26624
    s_waitcnt vmcnt(10)
    ds_write_b128 v11, v[188:191] offset:26752
    s_waitcnt vmcnt(9)
    ds_write_b128 v11, v[192:195] offset:26880
    s_waitcnt vmcnt(8)
    ds_write_b128 v11, v[196:199] offset:39936
    s_waitcnt vmcnt(7)
    ds_write_b128 v11, v[200:203] offset:40064
    s_waitcnt vmcnt(6)
    ds_write_b128 v11, v[204:207] offset:40192
    s_add_u32 s34, s33, 1032192
    buffer_load_dwordx4 v[184:187], v9, s[16:19], s34 offen offset:0
    buffer_load_dwordx4 v[188:191], v9, s[16:19], s34 offen offset:128
    buffer_load_dwordx4 v[192:195], v9, s[16:19], s34 offen offset:256
    buffer_load_dwordx4 v[196:199], v10, s[16:19], s34 offen offset:0
    buffer_load_dwordx4 v[200:203], v10, s[16:19], s34 offen offset:128
    buffer_load_dwordx4 v[204:207], v10, s[16:19], s34 offen offset:256
    ds_read_b128 v[120:123], v4 offset:24576
    ds_read_b128 v[124:127], v4 offset:24832
    ds_read_b128 v[128:131], v4 offset:25088
    ds_read_b128 v[132:135], v4 offset:25344
    ds_read_b64_tr_b16 v[152:153], v5 offset:0
    ds_read_b64_tr_b16 v[154:155], v5 offset:6656
    ds_read_b64_tr_b16 v[156:157], v5 offset:32
    ds_read_b64_tr_b16 v[158:159], v5 offset:6688
    ds_read_b64_tr_b16 v[160:161], v5 offset:64
    ds_read_b64_tr_b16 v[162:163], v5 offset:6720
    s_waitcnt lgkmcnt(15)
    v_mfma_f32_16x16x32_bf16 v[72:75], v[164:167], v[136:139], v[72:75]
    v_mfma_f32_16x16x32_bf16 v[76:79], v[168:171], v[136:139], v[76:79]
    v_mfma_f32_16x16x32_bf16 v[80:83], v[172:175], v[136:139], v[80:83]
    v_mfma_f32_16x16x32_bf16 v[84:87], v[164:167], v[140:143], v[84:87]
    v_mfma_f32_16x16x32_bf16 v[88:91], v[168:171], v[140:143], v[88:91]
    v_mfma_f32_16x16x32_bf16 v[92:95], v[172:175], v[140:143], v[92:95]
    v_mfma_f32_16x16x32_bf16 v[96:99], v[164:167], v[144:147], v[96:99]
    v_mfma_f32_16x16x32_bf16 v[100:103], v[168:171], v[144:147], v[100:103]
    v_mfma_f32_16x16x32_bf16 v[104:107], v[172:175], v[144:147], v[104:107]
    v_mfma_f32_16x16x32_bf16 v[108:111], v[164:167], v[148:151], v[108:111]
    v_mfma_f32_16x16x32_bf16 v[112:115], v[168:171], v[148:151], v[112:115]
    v_mfma_f32_16x16x32_bf16 v[116:119], v[172:175], v[148:151], v[116:119]
    s_waitcnt lgkmcnt(0)
    s_barrier
    ds_read_b128 v[136:139], v4 offset:28672
    ds_read_b128 v[140:143], v4 offset:28928
    ds_read_b128 v[144:147], v4 offset:29184
    ds_read_b128 v[148:151], v4 offset:29440
    ds_read_b64_tr_b16 v[164:165], v5 offset:13312
    ds_read_b64_tr_b16 v[166:167], v5 offset:19968
    ds_read_b64_tr_b16 v[168:169], v5 offset:13344
    ds_read_b64_tr_b16 v[170:171], v5 offset:20000
    ds_read_b64_tr_b16 v[172:173], v5 offset:13376
    ds_read_b64_tr_b16 v[174:175], v5 offset:20032
    v_mfma_f32_16x16x32_bf16 v[72:75], v[152:155], v[120:123], v[72:75]
    v_mfma_f32_16x16x32_bf16 v[76:79], v[156:159], v[120:123], v[76:79]
    v_mfma_f32_16x16x32_bf16 v[80:83], v[160:163], v[120:123], v[80:83]
    v_mfma_f32_16x16x32_bf16 v[84:87], v[152:155], v[124:127], v[84:87]
    v_mfma_f32_16x16x32_bf16 v[88:91], v[156:159], v[124:127], v[88:91]
    v_mfma_f32_16x16x32_bf16 v[92:95], v[160:163], v[124:127], v[92:95]
    v_mfma_f32_16x16x32_bf16 v[96:99], v[152:155], v[128:131], v[96:99]
    v_mfma_f32_16x16x32_bf16 v[100:103], v[156:159], v[128:131], v[100:103]
    v_mfma_f32_16x16x32_bf16 v[104:107], v[160:163], v[128:131], v[104:107]
    v_mfma_f32_16x16x32_bf16 v[108:111], v[152:155], v[132:135], v[108:111]
    v_mfma_f32_16x16x32_bf16 v[112:115], v[156:159], v[132:135], v[112:115]
    v_mfma_f32_16x16x32_bf16 v[116:119], v[160:163], v[132:135], v[116:119]
    s_waitcnt vmcnt(11)
    ds_write_b128 v7, v[208:211] offset:0
    s_waitcnt vmcnt(10)
    ds_write_b128 v7, v[212:215] offset:128
    s_waitcnt vmcnt(9)
    ds_write_b128 v7, v[216:219] offset:256
    s_waitcnt vmcnt(8)
    ds_write_b128 v7, v[220:223] offset:13312
    s_waitcnt vmcnt(7)
    ds_write_b128 v7, v[224:227] offset:13440
    s_waitcnt vmcnt(6)
    ds_write_b128 v7, v[228:231] offset:13568
    ds_read_b128 v[120:123], v4 offset:32768
    ds_read_b128 v[124:127], v4 offset:33024
    ds_read_b128 v[128:131], v4 offset:33280
    ds_read_b128 v[132:135], v4 offset:33536
    ds_read_b64_tr_b16 v[152:153], v5 offset:26624
    ds_read_b64_tr_b16 v[154:155], v5 offset:33280
    ds_read_b64_tr_b16 v[156:157], v5 offset:26656
    ds_read_b64_tr_b16 v[158:159], v5 offset:33312
    ds_read_b64_tr_b16 v[160:161], v5 offset:26688
    ds_read_b64_tr_b16 v[162:163], v5 offset:33344
    s_waitcnt lgkmcnt(15)
    v_mfma_f32_16x16x32_bf16 v[72:75], v[164:167], v[136:139], v[72:75]
    v_mfma_f32_16x16x32_bf16 v[76:79], v[168:171], v[136:139], v[76:79]
    v_mfma_f32_16x16x32_bf16 v[80:83], v[172:175], v[136:139], v[80:83]
    v_mfma_f32_16x16x32_bf16 v[84:87], v[164:167], v[140:143], v[84:87]
    v_mfma_f32_16x16x32_bf16 v[88:91], v[168:171], v[140:143], v[88:91]
    v_mfma_f32_16x16x32_bf16 v[92:95], v[172:175], v[140:143], v[92:95]
    v_mfma_f32_16x16x32_bf16 v[96:99], v[164:167], v[144:147], v[96:99]
    v_mfma_f32_16x16x32_bf16 v[100:103], v[168:171], v[144:147], v[100:103]
    v_mfma_f32_16x16x32_bf16 v[104:107], v[172:175], v[144:147], v[104:107]
    v_mfma_f32_16x16x32_bf16 v[108:111], v[164:167], v[148:151], v[108:111]
    v_mfma_f32_16x16x32_bf16 v[112:115], v[168:171], v[148:151], v[112:115]
    v_mfma_f32_16x16x32_bf16 v[116:119], v[172:175], v[148:151], v[116:119]
    s_waitcnt lgkmcnt(0)
    s_barrier
    ds_read_b128 v[136:139], v4 offset:36864
    ds_read_b128 v[140:143], v4 offset:37120
    ds_read_b128 v[144:147], v4 offset:37376
    ds_read_b128 v[148:151], v4 offset:37632
    ds_read_b64_tr_b16 v[164:165], v5 offset:39936
    ds_read_b64_tr_b16 v[166:167], v5 offset:46592
    ds_read_b64_tr_b16 v[168:169], v5 offset:39968
    ds_read_b64_tr_b16 v[170:171], v5 offset:46624
    ds_read_b64_tr_b16 v[172:173], v5 offset:40000
    ds_read_b64_tr_b16 v[174:175], v5 offset:46656
    v_mfma_f32_16x16x32_bf16 v[72:75], v[152:155], v[120:123], v[72:75]
    v_mfma_f32_16x16x32_bf16 v[76:79], v[156:159], v[120:123], v[76:79]
    v_mfma_f32_16x16x32_bf16 v[80:83], v[160:163], v[120:123], v[80:83]
    v_mfma_f32_16x16x32_bf16 v[84:87], v[152:155], v[124:127], v[84:87]
    v_mfma_f32_16x16x32_bf16 v[88:91], v[156:159], v[124:127], v[88:91]
    v_mfma_f32_16x16x32_bf16 v[92:95], v[160:163], v[124:127], v[92:95]
    v_mfma_f32_16x16x32_bf16 v[96:99], v[152:155], v[128:131], v[96:99]
    v_mfma_f32_16x16x32_bf16 v[100:103], v[156:159], v[128:131], v[100:103]
    v_mfma_f32_16x16x32_bf16 v[104:107], v[160:163], v[128:131], v[104:107]
    v_mfma_f32_16x16x32_bf16 v[108:111], v[152:155], v[132:135], v[108:111]
    v_mfma_f32_16x16x32_bf16 v[112:115], v[156:159], v[132:135], v[112:115]
    v_mfma_f32_16x16x32_bf16 v[116:119], v[160:163], v[132:135], v[116:119]
    s_waitcnt vmcnt(5)
    ds_write_b128 v11, v[184:187] offset:0
    s_waitcnt vmcnt(4)
    ds_write_b128 v11, v[188:191] offset:128
    s_waitcnt vmcnt(3)
    ds_write_b128 v11, v[192:195] offset:256
    s_waitcnt vmcnt(2)
    ds_write_b128 v11, v[196:199] offset:13312
    s_waitcnt vmcnt(1)
    ds_write_b128 v11, v[200:203] offset:13440
    s_waitcnt vmcnt(0)
    ds_write_b128 v11, v[204:207] offset:13568
    ds_read_b128 v[120:123], v4 offset:40960
    ds_read_b128 v[124:127], v4 offset:41216
    ds_read_b128 v[128:131], v4 offset:41472
    ds_read_b128 v[132:135], v4 offset:41728
    ds_read_b64_tr_b16 v[152:153], v6 offset:0
    ds_read_b64_tr_b16 v[154:155], v6 offset:6656
    ds_read_b64_tr_b16 v[156:157], v6 offset:32
    ds_read_b64_tr_b16 v[158:159], v6 offset:6688
    ds_read_b64_tr_b16 v[160:161], v6 offset:64
    ds_read_b64_tr_b16 v[162:163], v6 offset:6720
    s_waitcnt lgkmcnt(15)
    v_mfma_f32_16x16x32_bf16 v[72:75], v[164:167], v[136:139], v[72:75]
    v_mfma_f32_16x16x32_bf16 v[76:79], v[168:171], v[136:139], v[76:79]
    v_mfma_f32_16x16x32_bf16 v[80:83], v[172:175], v[136:139], v[80:83]
    v_mfma_f32_16x16x32_bf16 v[84:87], v[164:167], v[140:143], v[84:87]
    v_mfma_f32_16x16x32_bf16 v[88:91], v[168:171], v[140:143], v[88:91]
    v_mfma_f32_16x16x32_bf16 v[92:95], v[172:175], v[140:143], v[92:95]
    v_mfma_f32_16x16x32_bf16 v[96:99], v[164:167], v[144:147], v[96:99]
    v_mfma_f32_16x16x32_bf16 v[100:103], v[168:171], v[144:147], v[100:103]
    v_mfma_f32_16x16x32_bf16 v[104:107], v[172:175], v[144:147], v[104:107]
    v_mfma_f32_16x16x32_bf16 v[108:111], v[164:167], v[148:151], v[108:111]
    v_mfma_f32_16x16x32_bf16 v[112:115], v[168:171], v[148:151], v[112:115]
    v_mfma_f32_16x16x32_bf16 v[116:119], v[172:175], v[148:151], v[116:119]
    s_waitcnt lgkmcnt(0)
    s_barrier
    ds_read_b128 v[136:139], v4 offset:45056
    ds_read_b128 v[140:143], v4 offset:45312
    ds_read_b128 v[144:147], v4 offset:45568
    ds_read_b128 v[148:151], v4 offset:45824
    ds_read_b64_tr_b16 v[164:165], v6 offset:13312
    ds_read_b64_tr_b16 v[166:167], v6 offset:19968
    ds_read_b64_tr_b16 v[168:169], v6 offset:13344
    ds_read_b64_tr_b16 v[170:171], v6 offset:20000
    ds_read_b64_tr_b16 v[172:173], v6 offset:13376
    ds_read_b64_tr_b16 v[174:175], v6 offset:20032
    v_mfma_f32_16x16x32_bf16 v[72:75], v[152:155], v[120:123], v[72:75]
    v_mfma_f32_16x16x32_bf16 v[76:79], v[156:159], v[120:123], v[76:79]
    v_mfma_f32_16x16x32_bf16 v[80:83], v[160:163], v[120:123], v[80:83]
    v_mfma_f32_16x16x32_bf16 v[84:87], v[152:155], v[124:127], v[84:87]
    v_mfma_f32_16x16x32_bf16 v[88:91], v[156:159], v[124:127], v[88:91]
    v_mfma_f32_16x16x32_bf16 v[92:95], v[160:163], v[124:127], v[92:95]
    v_mfma_f32_16x16x32_bf16 v[96:99], v[152:155], v[128:131], v[96:99]
    v_mfma_f32_16x16x32_bf16 v[100:103], v[156:159], v[128:131], v[100:103]
    v_mfma_f32_16x16x32_bf16 v[104:107], v[160:163], v[128:131], v[104:107]
    v_mfma_f32_16x16x32_bf16 v[108:111], v[152:155], v[132:135], v[108:111]
    v_mfma_f32_16x16x32_bf16 v[112:115], v[156:159], v[132:135], v[112:115]
    v_mfma_f32_16x16x32_bf16 v[116:119], v[160:163], v[132:135], v[116:119]
    ds_read_b128 v[120:123], v4 offset:49152
    ds_read_b128 v[124:127], v4 offset:49408
    ds_read_b128 v[128:131], v4 offset:49664
    ds_read_b128 v[132:135], v4 offset:49920
    ds_read_b64_tr_b16 v[152:153], v5 offset:0
    ds_read_b64_tr_b16 v[154:155], v5 offset:6656
    ds_read_b64_tr_b16 v[156:157], v5 offset:32
    ds_read_b64_tr_b16 v[158:159], v5 offset:6688
    ds_read_b64_tr_b16 v[160:161], v5 offset:64
    ds_read_b64_tr_b16 v[162:163], v5 offset:6720
    s_waitcnt lgkmcnt(14)
    v_mfma_f32_16x16x32_bf16 v[72:75], v[164:167], v[136:139], v[72:75]
    s_waitcnt lgkmcnt(12)
    v_mfma_f32_16x16x32_bf16 v[76:79], v[168:171], v[136:139], v[76:79]
    s_waitcnt lgkmcnt(10)
    v_mfma_f32_16x16x32_bf16 v[80:83], v[172:175], v[136:139], v[80:83]
    v_mfma_f32_16x16x32_bf16 v[84:87], v[164:167], v[140:143], v[84:87]
    v_mfma_f32_16x16x32_bf16 v[88:91], v[168:171], v[140:143], v[88:91]
    v_mfma_f32_16x16x32_bf16 v[92:95], v[172:175], v[140:143], v[92:95]
    v_mfma_f32_16x16x32_bf16 v[96:99], v[164:167], v[144:147], v[96:99]
    v_mfma_f32_16x16x32_bf16 v[100:103], v[168:171], v[144:147], v[100:103]
    v_mfma_f32_16x16x32_bf16 v[104:107], v[172:175], v[144:147], v[104:107]
    v_mfma_f32_16x16x32_bf16 v[108:111], v[164:167], v[148:151], v[108:111]
    v_mfma_f32_16x16x32_bf16 v[112:115], v[168:171], v[148:151], v[112:115]
    v_mfma_f32_16x16x32_bf16 v[116:119], v[172:175], v[148:151], v[116:119]
    s_waitcnt lgkmcnt(0)
    s_barrier
    ds_read_b128 v[136:139], v4 offset:53248
    ds_read_b128 v[140:143], v4 offset:53504
    ds_read_b128 v[144:147], v4 offset:53760
    ds_read_b128 v[148:151], v4 offset:54016
    ds_read_b64_tr_b16 v[164:165], v5 offset:13312
    ds_read_b64_tr_b16 v[166:167], v5 offset:19968
    ds_read_b64_tr_b16 v[168:169], v5 offset:13344
    ds_read_b64_tr_b16 v[170:171], v5 offset:20000
    ds_read_b64_tr_b16 v[172:173], v5 offset:13376
    ds_read_b64_tr_b16 v[174:175], v5 offset:20032
    v_mfma_f32_16x16x32_bf16 v[72:75], v[152:155], v[120:123], v[72:75]
    v_mfma_f32_16x16x32_bf16 v[76:79], v[156:159], v[120:123], v[76:79]
    v_mfma_f32_16x16x32_bf16 v[80:83], v[160:163], v[120:123], v[80:83]
    v_mfma_f32_16x16x32_bf16 v[84:87], v[152:155], v[124:127], v[84:87]
    v_mfma_f32_16x16x32_bf16 v[88:91], v[156:159], v[124:127], v[88:91]
    v_mfma_f32_16x16x32_bf16 v[92:95], v[160:163], v[124:127], v[92:95]
    v_mfma_f32_16x16x32_bf16 v[96:99], v[152:155], v[128:131], v[96:99]
    v_mfma_f32_16x16x32_bf16 v[100:103], v[156:159], v[128:131], v[100:103]
    v_mfma_f32_16x16x32_bf16 v[104:107], v[160:163], v[128:131], v[104:107]
    v_mfma_f32_16x16x32_bf16 v[108:111], v[152:155], v[132:135], v[108:111]
    v_mfma_f32_16x16x32_bf16 v[112:115], v[156:159], v[132:135], v[112:115]
    v_mfma_f32_16x16x32_bf16 v[116:119], v[160:163], v[132:135], v[116:119]
    s_waitcnt lgkmcnt(4)
    v_mfma_f32_16x16x32_bf16 v[72:75], v[164:167], v[136:139], v[72:75]
    s_waitcnt lgkmcnt(2)
    v_mfma_f32_16x16x32_bf16 v[76:79], v[168:171], v[136:139], v[76:79]
    s_waitcnt lgkmcnt(0)
    v_mfma_f32_16x16x32_bf16 v[80:83], v[172:175], v[136:139], v[80:83]
    v_mfma_f32_16x16x32_bf16 v[84:87], v[164:167], v[140:143], v[84:87]
    v_mfma_f32_16x16x32_bf16 v[88:91], v[168:171], v[140:143], v[88:91]
    v_mfma_f32_16x16x32_bf16 v[92:95], v[172:175], v[140:143], v[92:95]
    v_mfma_f32_16x16x32_bf16 v[96:99], v[164:167], v[144:147], v[96:99]
    v_mfma_f32_16x16x32_bf16 v[100:103], v[168:171], v[144:147], v[100:103]
    v_mfma_f32_16x16x32_bf16 v[104:107], v[172:175], v[144:147], v[104:107]
    v_mfma_f32_16x16x32_bf16 v[108:111], v[164:167], v[148:151], v[108:111]
    v_mfma_f32_16x16x32_bf16 v[112:115], v[168:171], v[148:151], v[112:115]
    v_mfma_f32_16x16x32_bf16 v[116:119], v[172:175], v[148:151], v[116:119]
    s_mul_i32 s35, s2, 192
    s_mul_i32 s36, s28, 48
    s_add_u32 s35, s35, s36
    v_lshlrev_b32 v5, 2, v3
    v_add_u32 v5, s35, v5
    s_lshl_b32 s36, s3, 6
    v_add_u32 v7, s36, v2
    v_mul_u32_u24 v7, 56, v7
    s_mov_b32 s37, 9363
    s_mov_b32 s38, 114632
    v_add_u32 v8, 0, v5
    v_mul_lo_u32 v9, v8, s37
    v_lshrrev_b32 v9, 18, v9
    v_mul_lo_u32 v9, v9, s38
    v_lshl_add_u32 v9, v8, 1, v9
    v_add_u32 v10, v9, v7
    v_add_u32 v8, 16, v5
    v_mul_lo_u32 v9, v8, s37
    v_lshrrev_b32 v9, 18, v9
    v_mul_lo_u32 v9, v9, s38
    v_lshl_add_u32 v9, v8, 1, v9
    v_add_u32 v11, v9, v7
    v_add_u32 v8, 32, v5
    v_mul_lo_u32 v9, v8, s37
    v_lshrrev_b32 v9, 18, v9
    v_mul_lo_u32 v9, v9, s38
    v_lshl_add_u32 v9, v8, 1, v9
    v_add_u32 v12, v9, v7
    v_cvt_pk_bf16_f32 v72, v72, v73
    v_cvt_pk_bf16_f32 v73, v74, v75
    buffer_store_dwordx2 v[72:73], v10, s[20:23], 0 offen offset:0
    v_cvt_pk_bf16_f32 v76, v76, v77
    v_cvt_pk_bf16_f32 v77, v78, v79
    buffer_store_dwordx2 v[76:77], v11, s[20:23], 0 offen offset:0
    v_cvt_pk_bf16_f32 v80, v80, v81
    v_cvt_pk_bf16_f32 v81, v82, v83
    buffer_store_dwordx2 v[80:81], v12, s[20:23], 0 offen offset:0
    v_cvt_pk_bf16_f32 v84, v84, v85
    v_cvt_pk_bf16_f32 v85, v86, v87
    buffer_store_dwordx2 v[84:85], v10, s[20:23], 0 offen offset:896
    v_cvt_pk_bf16_f32 v88, v88, v89
    v_cvt_pk_bf16_f32 v89, v90, v91
    buffer_store_dwordx2 v[88:89], v11, s[20:23], 0 offen offset:896
    v_cvt_pk_bf16_f32 v92, v92, v93
    v_cvt_pk_bf16_f32 v93, v94, v95
    buffer_store_dwordx2 v[92:93], v12, s[20:23], 0 offen offset:896
    v_cvt_pk_bf16_f32 v96, v96, v97
    v_cvt_pk_bf16_f32 v97, v98, v99
    buffer_store_dwordx2 v[96:97], v10, s[20:23], 0 offen offset:1792
    v_cvt_pk_bf16_f32 v100, v100, v101
    v_cvt_pk_bf16_f32 v101, v102, v103
    buffer_store_dwordx2 v[100:101], v11, s[20:23], 0 offen offset:1792
    v_cvt_pk_bf16_f32 v104, v104, v105
    v_cvt_pk_bf16_f32 v105, v106, v107
    buffer_store_dwordx2 v[104:105], v12, s[20:23], 0 offen offset:1792
    v_cvt_pk_bf16_f32 v108, v108, v109
    v_cvt_pk_bf16_f32 v109, v110, v111
    buffer_store_dwordx2 v[108:109], v10, s[20:23], 0 offen offset:2688
    v_cvt_pk_bf16_f32 v112, v112, v113
    v_cvt_pk_bf16_f32 v113, v114, v115
    buffer_store_dwordx2 v[112:113], v11, s[20:23], 0 offen offset:2688
    v_cvt_pk_bf16_f32 v116, v116, v117
    v_cvt_pk_bf16_f32 v117, v118, v119
    buffer_store_dwordx2 v[116:117], v12, s[20:23], 0 offen offset:2688
    s_waitcnt vmcnt(0)
k1_done:
    s_endpgm
.section .rodata,"a"
.p2align 6
.amdhsa_kernel k1_kernel
  .amdhsa_next_free_vgpr 240
  .amdhsa_next_free_sgpr 96
  .amdhsa_accum_offset 240
  .amdhsa_group_segment_fixed_size 0
  .amdhsa_kernarg_size 88
  .amdhsa_user_sgpr_count 2
  .amdhsa_user_sgpr_kernarg_segment_ptr 1
  .amdhsa_system_sgpr_workgroup_id_x 1
.end_amdhsa_kernel
.text
.globl k2_kernel
.p2align 8
.type k2_kernel,@function
k2_kernel:
    s_cmp_ge_u32 s2, 256
    s_cbranch_scc1 k2_ffn
    s_load_dwordx2 s[4:5], s[0:1], 80
    v_and_b32 v1, 63, v0
    v_and_b32 v2, 15, v0
    v_bfe_u32 v3, v0, 4, 2
    v_lshrrev_b32 v5, 6, v0
    s_nop 0
    v_readfirstlane_b32 s28, v5
    s_and_b32 s29, s2, 7
    s_lshl_b32 s29, s29, 1
    s_lshr_b32 s30, s2, 3
    s_lshr_b32 s31, s30, 4
    s_add_u32 s29, s29, s31
    s_and_b32 s30, s30, 15
    s_waitcnt lgkmcnt(0)
    s_mov_b32 s8, s4
    s_mov_b32 s9, s5
    s_mov_b32 s10, 0x70b000
    s_mov_b32 s11, 0x00020000
    s_mul_i32 s31, s29, 114688
    s_mul_i32 s32, s30, 7168
    s_add_u32 s31, s31, s32
    s_add_u32 s33, s31, 1820672
    s_add_u32 s34, s33, 1835008
    v_lshlrev_b32 v4, 4, v0
    v_add_u32 v5, 8192, v4
    v_add_u32 v6, 16384, v4
    buffer_load_dwordx4 v[36:39], v4, s[8:11], s33 offen
    buffer_load_dwordx4 v[40:43], v5, s[8:11], s33 offen
    buffer_load_dwordx4 v[44:47], v6, s[8:11], s33 offen
    buffer_load_dwordx4 v[48:51], v4, s[8:11], s34 offen
    buffer_load_dwordx4 v[52:55], v5, s[8:11], s34 offen
    buffer_load_dwordx4 v[56:59], v6, s[8:11], s34 offen
    s_lshl_b32 s35, s28, 4
    v_add_u32 v7, s35, v2
    v_mul_u32_u24 v7, 56, v7
    v_lshl_add_u32 v7, v3, 4, v7
    buffer_load_dwordx2 v[16:17], v7, s[8:11], s31 offen
    buffer_load_dwordx2 v[18:19], v7, s[8:11], s31 offen offset:8
    s_lshl_b32 s36, s30, 3
    s_add_u32 s36, s36, s28
    s_sub_i32 s36, 16, s36
    s_max_i32 s36, s36, 0
    s_mov_b32 s37, 0xf149f2ca
    v_lshlrev_b32 v8, 2, v3
    v_sub_u32 v8, v8, v2
    s_cmp_gt_i32 s36, 0
    s_cselect_b32 s38, -1000, 0
    v_add_u32 v9, s38, v8
    v_mov_b32 v10, s37
    v_cmp_lt_i32 vcc, 0, v9
    s_nop 1
    v_cndmask_b32 v20, v10, 0, vcc
    v_cmp_lt_i32 vcc, -1, v9
    s_nop 1
    v_cndmask_b32 v21, v10, 0, vcc
    v_cmp_lt_i32 vcc, -2, v9
    s_nop 1
    v_cndmask_b32 v22, v10, 0, vcc
    v_cmp_lt_i32 vcc, -3, v9
    s_nop 1
    v_cndmask_b32 v23, v10, 0, vcc
    v_cmp_ge_i32 vcc, 0, v8
    s_nop 1
    v_cndmask_b32 v24, v10, 0, vcc
    v_cmp_ge_i32 vcc, -1, v8
    s_nop 1
    v_cndmask_b32 v25, v10, 0, vcc
    v_cmp_ge_i32 vcc, -2, v8
    s_nop 1
    v_cndmask_b32 v26, v10, 0, vcc
    v_cmp_ge_i32 vcc, -3, v8
    s_nop 1
    v_cndmask_b32 v27, v10, 0, vcc
    v_cmp_eq_u32 vcc, 3, v3
    s_waitcnt vmcnt(0)
    s_nop 0
    v_cndmask_b32 v18, v18, 0, vcc
    v_cndmask_b32 v19, v19, 0, vcc
    ds_write_b128 v4, v[36:39] offset:0
    ds_write_b128 v4, v[40:43] offset:8192
    ds_write_b128 v4, v[44:47] offset:16384
    ds_write_b128 v4, v[48:51] offset:24576
    ds_write_b128 v4, v[52:55] offset:32768
    ds_write_b128 v4, v[56:59] offset:40960
    s_waitcnt lgkmcnt(0)
    s_barrier
    ds_read_b64 v[104:105], v7 offset:0
    ds_read_b64 v[106:107], v7 offset:8
    ds_read_b64 v[108:109], v7 offset:896
    ds_read_b64 v[110:111], v7 offset:904
    ds_read_b64 v[112:113], v7 offset:1792
    ds_read_b64 v[114:115], v7 offset:1800
    ds_read_b64 v[116:117], v7 offset:2688
    ds_read_b64 v[118:119], v7 offset:2696
    ds_read_b64 v[120:121], v7 offset:3584
    ds_read_b64 v[122:123], v7 offset:3592
    ds_read_b64 v[124:125], v7 offset:4480
    ds_read_b64 v[126:127], v7 offset:4488
    s_waitcnt lgkmcnt(10)
    v_mfma_f32_16x16x32_bf16 v[36:39], v[104:107], v[16:19], v[20:23]
    ds_read_b64 v[104:105], v7 offset:5376
    ds_read_b64 v[106:107], v7 offset:5384
    s_cmp_gt_i32 s36, 1
    s_cselect_b32 s38, s37, 0
    v_mov_b32 v32, s38
    v_mov_b32 v33, s38
    v_mov_b32 v34, s38
    v_mov_b32 v35, s38
    s_waitcnt lgkmcnt(10)
    s_nop 0
    v_mfma_f32_16x16x32_bf16 v[40:43], v[108:111], v[16:19], v[32:35]
    ds_read_b64 v[108:109], v7 offset:6272
    ds_read_b64 v[110:111], v7 offset:6280
    s_cmp_gt_i32 s36, 2
    s_cselect_b32 s38, s37, 0
    v_mov_b32 v28, s38
    v_mov_b32 v29, s38
    v_mov_b32 v30, s38
    v_mov_b32 v31, s38
    s_waitcnt lgkmcnt(10)
    s_nop 0
    v_mfma_f32_16x16x32_bf16 v[44:47], v[112:115], v[16:19], v[28:31]
    ds_read_b64 v[112:113], v7 offset:7168
    ds_read_b64 v[114:115], v7 offset:7176
    s_cmp_gt_i32 s36, 3
    s_cselect_b32 s38, s37, 0
    v_mov_b32 v32, s38
    v_mov_b32 v33, s38
    v_mov_b32 v34, s38
    v_mov_b32 v35, s38
    s_waitcnt lgkmcnt(10)
    s_nop 0
    v_mfma_f32_16x16x32_bf16 v[48:51], v[116:119], v[16:19], v[32:35]
    ds_read_b64 v[116:117], v7 offset:8064
    ds_read_b64 v[118:119], v7 offset:8072
    s_cmp_gt_i32 s36, 4
    s_cselect_b32 s38, s37, 0
    v_mov_b32 v28, s38
    v_mov_b32 v29, s38
    v_mov_b32 v30, s38
    v_mov_b32 v31, s38
    s_waitcnt lgkmcnt(10)
    s_nop 0
    v_mfma_f32_16x16x32_bf16 v[52:55], v[120:123], v[16:19], v[28:31]
    ds_read_b64 v[120:121], v7 offset:8960
    ds_read_b64 v[122:123], v7 offset:8968
    s_cmp_gt_i32 s36, 5
    s_cselect_b32 s38, s37, 0
    v_mov_b32 v32, s38
    v_mov_b32 v33, s38
    v_mov_b32 v34, s38
    v_mov_b32 v35, s38
    s_waitcnt lgkmcnt(10)
    s_nop 0
    v_mfma_f32_16x16x32_bf16 v[56:59], v[124:127], v[16:19], v[32:35]
    ds_read_b64 v[124:125], v7 offset:9856
    ds_read_b64 v[126:127], v7 offset:9864
    s_cmp_gt_i32 s36, 6
    s_cselect_b32 s38, s37, 0
    v_mov_b32 v28, s38
    v_mov_b32 v29, s38
    v_mov_b32 v30, s38
    v_mov_b32 v31, s38
    s_waitcnt lgkmcnt(10)
    s_nop 0
    v_mfma_f32_16x16x32_bf16 v[60:63], v[104:107], v[16:19], v[28:31]
    ds_read_b64 v[104:105], v7 offset:10752
    ds_read_b64 v[106:107], v7 offset:10760
    s_cmp_gt_i32 s36, 7
    s_cselect_b32 s38, s37, 0
    v_mov_b32 v32, s38
    v_mov_b32 v33, s38
    v_mov_b32 v34, s38
    v_mov_b32 v35, s38
    s_waitcnt lgkmcnt(10)
    s_nop 0
    v_mfma_f32_16x16x32_bf16 v[64:67], v[108:111], v[16:19], v[32:35]
    ds_read_b64 v[108:109], v7 offset:11648
    ds_read_b64 v[110:111], v7 offset:11656
    s_cmp_gt_i32 s36, 8
    s_cselect_b32 s38, s37, 0
    v_mov_b32 v28, s38
    v_mov_b32 v29, s38
    v_mov_b32 v30, s38
    v_mov_b32 v31, s38
    s_waitcnt lgkmcnt(10)
    s_nop 0
    v_mfma_f32_16x16x32_bf16 v[68:71], v[112:115], v[16:19], v[28:31]
    ds_read_b64 v[112:113], v7 offset:12544
    ds_read_b64 v[114:115], v7 offset:12552
    s_cmp_gt_i32 s36, 9
    s_cselect_b32 s38, s37, 0
    v_mov_b32 v32, s38
    v_mov_b32 v33, s38
    v_mov_b32 v34, s38
    v_mov_b32 v35, s38
    s_waitcnt lgkmcnt(10)
    s_nop 0
    v_mfma_f32_16x16x32_bf16 v[72:75], v[116:119], v[16:19], v[32:35]
    ds_read_b64 v[116:117], v7 offset:13440
    ds_read_b64 v[118:119], v7 offset:13448
    s_cmp_gt_i32 s36, 10
    s_cselect_b32 s38, s37, 0
    v_mov_b32 v28, s38
    v_mov_b32 v29, s38
    v_mov_b32 v30, s38
    v_mov_b32 v31, s38
    s_waitcnt lgkmcnt(10)
    s_nop 0
    v_mfma_f32_16x16x32_bf16 v[76:79], v[120:123], v[16:19], v[28:31]
    ds_read_b64 v[120:121], v7 offset:14336
    ds_read_b64 v[122:123], v7 offset:14344
    s_cmp_gt_i32 s36, 11
    s_cselect_b32 s38, s37, 0
    v_mov_b32 v32, s38
    v_mov_b32 v33, s38
    v_mov_b32 v34, s38
    v_mov_b32 v35, s38
    s_waitcnt lgkmcnt(10)
    s_nop 0
    v_mfma_f32_16x16x32_bf16 v[80:83], v[124:127], v[16:19], v[32:35]
    s_cmp_gt_i32 s36, 12
    s_cselect_b32 s38, s37, 0
    v_mov_b32 v28, s38
    v_mov_b32 v29, s38
    v_mov_b32 v30, s38
    v_mov_b32 v31, s38
    s_waitcnt lgkmcnt(8)
    s_nop 0
    v_mfma_f32_16x16x32_bf16 v[84:87], v[104:107], v[16:19], v[28:31]
    s_cmp_gt_i32 s36, 13
    s_cselect_b32 s38, s37, 0
    v_mov_b32 v32, s38
    v_mov_b32 v33, s38
    v_mov_b32 v34, s38
    v_mov_b32 v35, s38
    s_waitcnt lgkmcnt(6)
    s_nop 0
    v_mfma_f32_16x16x32_bf16 v[88:91], v[108:111], v[16:19], v[32:35]
    s_cmp_gt_i32 s36, 14
    s_cselect_b32 s38, s37, 0
    v_mov_b32 v28, s38
    v_mov_b32 v29, s38
    v_mov_b32 v30, s38
    v_mov_b32 v31, s38
    s_waitcnt lgkmcnt(4)
    s_nop 0
    v_mfma_f32_16x16x32_bf16 v[92:95], v[112:115], v[16:19], v[28:31]
    s_cmp_gt_i32 s36, 15
    s_cselect_b32 s38, s37, 0
    v_mov_b32 v32, s38
    v_mov_b32 v33, s38
    v_mov_b32 v34, s38
    v_mov_b32 v35, s38
    s_waitcnt lgkmcnt(2)
    s_nop 0
    v_mfma_f32_16x16x32_bf16 v[96:99], v[116:119], v[16:19], v[32:35]
    s_waitcnt lgkmcnt(0)
    v_mfma_f32_16x16x32_bf16 v[100:103], v[120:123], v[16:19], v[24:27]
    v_bfe_u32 v11, v0, 2, 4
    v_add_u32 v11, s35, v11
    v_mul_u32_u24 v11, 56, v11
    v_and_b32 v12, 3, v0
    v_lshl_add_u32 v11, v12, 3, v11
    v_add_u32 v11, 24576, v11
    v_max3_f32 v12, v36, v37, v38
    v_max3_f32 v12, v12, v39, v40
    v_max3_f32 v12, v12, v41, v42
    v_max3_f32 v12, v12, v43, v44
    v_max3_f32 v12, v12, v45, v46
    v_max3_f32 v12, v12, v47, v48
    v_max3_f32 v12, v12, v49, v50
    v_max3_f32 v12, v12, v51, v52
    v_max3_f32 v12, v12, v53, v54
    v_max3_f32 v12, v12, v55, v56
    v_max3_f32 v12, v12, v57, v58
    v_max3_f32 v12, v12, v59, v60
    v_max3_f32 v12, v12, v61, v62
    v_max3_f32 v12, v12, v63, v64
    v_max3_f32 v12, v12, v65, v66
    v_max3_f32 v12, v12, v67, v68
    v_max3_f32 v12, v12, v69, v70
    v_max3_f32 v12, v12, v71, v72
    v_max3_f32 v12, v12, v73, v74
    v_max3_f32 v12, v12, v75, v76
    v_max3_f32 v12, v12, v77, v78
    v_max3_f32 v12, v12, v79, v80
    v_max3_f32 v12, v12, v81, v82
    v_max3_f32 v12, v12, v83, v84
    v_max3_f32 v12, v12, v85, v86
    v_max3_f32 v12, v12, v87, v88
    v_max3_f32 v12, v12, v89, v90
    v_max3_f32 v12, v12, v91, v92
    v_max3_f32 v12, v12, v93, v94
    v_max3_f32 v12, v12, v95, v96
    v_max3_f32 v12, v12, v97, v98
    v_max3_f32 v12, v12, v99, v100
    v_max3_f32 v12, v12, v101, v102
    v_max_f32 v12, v12, v103
    v_xor_b32 v13, 16, v1
    v_lshlrev_b32 v13, 2, v13
    v_xor_b32 v14, 32, v1
    v_lshlrev_b32 v14, 2, v14
    ds_bpermute_b32 v15, v13, v12
    s_waitcnt lgkmcnt(0)
    v_max_f32 v12, v12, v15
    ds_bpermute_b32 v15, v14, v12
    s_waitcnt lgkmcnt(0)
    v_max_f32 v12, v12, v15
    s_mov_b32 s39, 0x3e8b97f6
    v_mul_f32 v12, s39, v12
    v_fma_f32 v36, v36, s39, -v12
    v_fma_f32 v37, v37, s39, -v12
    v_fma_f32 v38, v38, s39, -v12
    v_fma_f32 v39, v39, s39, -v12
    v_fma_f32 v40, v40, s39, -v12
    v_fma_f32 v41, v41, s39, -v12
    v_fma_f32 v42, v42, s39, -v12
    v_fma_f32 v43, v43, s39, -v12
    v_fma_f32 v44, v44, s39, -v12
    v_fma_f32 v45, v45, s39, -v12
    v_fma_f32 v46, v46, s39, -v12
    v_fma_f32 v47, v47, s39, -v12
    v_fma_f32 v48, v48, s39, -v12
    v_fma_f32 v49, v49, s39, -v12
    v_fma_f32 v50, v50, s39, -v12
    v_fma_f32 v51, v51, s39, -v12
    v_fma_f32 v52, v52, s39, -v12
    v_fma_f32 v53, v53, s39, -v12
    v_fma_f32 v54, v54, s39, -v12
    v_fma_f32 v55, v55, s39, -v12
    v_fma_f32 v56, v56, s39, -v12
    v_fma_f32 v57, v57, s39, -v12
    v_fma_f32 v58, v58, s39, -v12
    v_fma_f32 v59, v59, s39, -v12
    v_fma_f32 v60, v60, s39, -v12
    v_fma_f32 v61, v61, s39, -v12
    v_fma_f32 v62, v62, s39, -v12
    v_fma_f32 v63, v63, s39, -v12
    v_fma_f32 v64, v64, s39, -v12
    v_fma_f32 v65, v65, s39, -v12
    v_fma_f32 v66, v66, s39, -v12
    v_fma_f32 v67, v67, s39, -v12
    v_fma_f32 v68, v68, s39, -v12
    v_fma_f32 v69, v69, s39, -v12
    v_fma_f32 v70, v70, s39, -v12
    v_fma_f32 v71, v71, s39, -v12
    v_fma_f32 v72, v72, s39, -v12
    v_fma_f32 v73, v73, s39, -v12
    v_fma_f32 v74, v74, s39, -v12
    v_fma_f32 v75, v75, s39, -v12
    v_fma_f32 v76, v76, s39, -v12
    v_fma_f32 v77, v77, s39, -v12
    v_fma_f32 v78, v78, s39, -v12
    v_fma_f32 v79, v79, s39, -v12
    v_fma_f32 v80, v80, s39, -v12
    v_fma_f32 v81, v81, s39, -v12
    v_fma_f32 v82, v82, s39, -v12
    v_fma_f32 v83, v83, s39, -v12
    v_fma_f32 v84, v84, s39, -v12
    v_fma_f32 v85, v85, s39, -v12
    v_fma_f32 v86, v86, s39, -v12
    v_fma_f32 v87, v87, s39, -v12
    v_fma_f32 v88, v88, s39, -v12
    v_fma_f32 v89, v89, s39, -v12
    v_fma_f32 v90, v90, s39, -v12
    v_fma_f32 v91, v91, s39, -v12
    v_fma_f32 v92, v92, s39, -v12
    v_fma_f32 v93, v93, s39, -v12
    v_fma_f32 v94, v94, s39, -v12
    v_fma_f32 v95, v95, s39, -v12
    v_fma_f32 v96, v96, s39, -v12
    v_fma_f32 v97, v97, s39, -v12
    v_fma_f32 v98, v98, s39, -v12
    v_fma_f32 v99, v99, s39, -v12
    v_fma_f32 v100, v100, s39, -v12
    v_fma_f32 v101, v101, s39, -v12
    v_fma_f32 v102, v102, s39, -v12
    v_fma_f32 v103, v103, s39, -v12
    v_exp_f32 v36, v36
    v_exp_f32 v37, v37
    v_exp_f32 v38, v38
    v_exp_f32 v39, v39
    v_exp_f32 v40, v40
    v_exp_f32 v41, v41
    v_exp_f32 v42, v42
    v_exp_f32 v43, v43
    v_exp_f32 v44, v44
    v_exp_f32 v45, v45
    v_exp_f32 v46, v46
    v_exp_f32 v47, v47
    v_exp_f32 v48, v48
    v_exp_f32 v49, v49
    v_exp_f32 v50, v50
    v_exp_f32 v51, v51
    v_exp_f32 v52, v52
    v_exp_f32 v53, v53
    v_exp_f32 v54, v54
    v_exp_f32 v55, v55
    v_exp_f32 v56, v56
    v_exp_f32 v57, v57
    v_exp_f32 v58, v58
    v_exp_f32 v59, v59
    v_exp_f32 v60, v60
    v_exp_f32 v61, v61
    v_exp_f32 v62, v62
    v_exp_f32 v63, v63
    v_exp_f32 v64, v64
    v_exp_f32 v65, v65
    v_exp_f32 v66, v66
    v_exp_f32 v67, v67
    v_exp_f32 v68, v68
    v_exp_f32 v69, v69
    v_exp_f32 v70, v70
    v_exp_f32 v71, v71
    v_exp_f32 v72, v72
    v_exp_f32 v73, v73
    v_exp_f32 v74, v74
    v_exp_f32 v75, v75
    v_exp_f32 v76, v76
    v_exp_f32 v77, v77
    v_exp_f32 v78, v78
    v_exp_f32 v79, v79
    v_exp_f32 v80, v80
    v_exp_f32 v81, v81
    v_exp_f32 v82, v82
    v_exp_f32 v83, v83
    v_exp_f32 v84, v84
    v_exp_f32 v85, v85
    v_exp_f32 v86, v86
    v_exp_f32 v87, v87
    v_exp_f32 v88, v88
    v_exp_f32 v89, v89
    v_exp_f32 v90, v90
    v_exp_f32 v91, v91
    v_exp_f32 v92, v92
    v_exp_f32 v93, v93
    v_exp_f32 v94, v94
    v_exp_f32 v95, v95
    v_exp_f32 v96, v96
    v_exp_f32 v97, v97
    v_exp_f32 v98, v98
    v_exp_f32 v99, v99
    v_exp_f32 v100, v100
    v_exp_f32 v101, v101
    v_exp_f32 v102, v102
    v_exp_f32 v103, v103
    v_pk_add_f32 v[8:9], v[36:37], v[38:39]
    v_pk_add_f32 v[8:9], v[8:9], v[40:41]
    v_pk_add_f32 v[8:9], v[8:9], v[42:43]
    v_pk_add_f32 v[8:9], v[8:9], v[44:45]
    v_pk_add_f32 v[8:9], v[8:9], v[46:47]
    v_pk_add_f32 v[8:9], v[8:9], v[48:49]
    v_pk_add_f32 v[8:9], v[8:9], v[50:51]
    v_pk_add_f32 v[8:9], v[8:9], v[52:53]
    v_pk_add_f32 v[8:9], v[8:9], v[54:55]
    v_pk_add_f32 v[8:9], v[8:9], v[56:57]
    v_pk_add_f32 v[8:9], v[8:9], v[58:59]
    v_pk_add_f32 v[8:9], v[8:9], v[60:61]
    v_pk_add_f32 v[8:9], v[8:9], v[62:63]
    v_pk_add_f32 v[8:9], v[8:9], v[64:65]
    v_pk_add_f32 v[8:9], v[8:9], v[66:67]
    v_pk_add_f32 v[8:9], v[8:9], v[68:69]
    v_pk_add_f32 v[8:9], v[8:9], v[70:71]
    v_pk_add_f32 v[8:9], v[8:9], v[72:73]
    v_pk_add_f32 v[8:9], v[8:9], v[74:75]
    v_pk_add_f32 v[8:9], v[8:9], v[76:77]
    v_pk_add_f32 v[8:9], v[8:9], v[78:79]
    v_pk_add_f32 v[8:9], v[8:9], v[80:81]
    v_pk_add_f32 v[8:9], v[8:9], v[82:83]
    v_pk_add_f32 v[8:9], v[8:9], v[84:85]
    v_pk_add_f32 v[8:9], v[8:9], v[86:87]
    v_pk_add_f32 v[8:9], v[8:9], v[88:89]
    v_pk_add_f32 v[8:9], v[8:9], v[90:91]
    v_pk_add_f32 v[8:9], v[8:9], v[92:93]
    v_pk_add_f32 v[8:9], v[8:9], v[94:95]
    v_pk_add_f32 v[8:9], v[8:9], v[96:97]
    v_pk_add_f32 v[8:9], v[8:9], v[98:99]
    v_pk_add_f32 v[8:9], v[8:9], v[100:101]
    v_pk_add_f32 v[8:9], v[8:9], v[102:103]
    v_add_f32 v8, v8, v9
    v_cvt_pk_bf16_f32 v36, v36, v37
    v_cvt_pk_bf16_f32 v37, v38, v39
    v_cvt_pk_bf16_f32 v38, v40, v41
    v_cvt_pk_bf16_f32 v39, v42, v43
    v_cvt_pk_bf16_f32 v40, v44, v45
    v_cvt_pk_bf16_f32 v41, v46, v47
    v_cvt_pk_bf16_f32 v42, v48, v49
    v_cvt_pk_bf16_f32 v43, v50, v51
    v_cvt_pk_bf16_f32 v44, v52, v53
    v_cvt_pk_bf16_f32 v45, v54, v55
    v_cvt_pk_bf16_f32 v46, v56, v57
    v_cvt_pk_bf16_f32 v47, v58, v59
    v_cvt_pk_bf16_f32 v48, v60, v61
    v_cvt_pk_bf16_f32 v49, v62, v63
    v_cvt_pk_bf16_f32 v50, v64, v65
    v_cvt_pk_bf16_f32 v51, v66, v67
    v_cvt_pk_bf16_f32 v52, v68, v69
    v_cvt_pk_bf16_f32 v53, v70, v71
    v_cvt_pk_bf16_f32 v54, v72, v73
    v_cvt_pk_bf16_f32 v55, v74, v75
    v_cvt_pk_bf16_f32 v56, v76, v77
    v_cvt_pk_bf16_f32 v57, v78, v79
    v_cvt_pk_bf16_f32 v58, v80, v81
    v_cvt_pk_bf16_f32 v59, v82, v83
    v_cvt_pk_bf16_f32 v60, v84, v85
    v_cvt_pk_bf16_f32 v61, v86, v87
    v_cvt_pk_bf16_f32 v62, v88, v89
    v_cvt_pk_bf16_f32 v63, v90, v91
    v_cvt_pk_bf16_f32 v64, v92, v93
    v_cvt_pk_bf16_f32 v65, v94, v95
    v_cvt_pk_bf16_f32 v66, v96, v97
    v_cvt_pk_bf16_f32 v67, v98, v99
    v_cvt_pk_bf16_f32 v68, v100, v101
    v_cvt_pk_bf16_f32 v69, v102, v103
    ds_bpermute_b32 v15, v13, v8
    s_waitcnt lgkmcnt(0)
    v_add_f32 v8, v8, v15
    ds_bpermute_b32 v15, v14, v8
    s_waitcnt lgkmcnt(0)
    v_add_f32 v8, v8, v15
    v_rcp_f32 v8, v8
    ds_read_b64_tr_b16 v[70:71], v11 offset:0
    ds_read_b64_tr_b16 v[72:73], v11 offset:896
    ds_read_b64_tr_b16 v[74:75], v11 offset:1792
    ds_read_b64_tr_b16 v[76:77], v11 offset:2688
    ds_read_b64_tr_b16 v[78:79], v11 offset:3584
    ds_read_b64_tr_b16 v[80:81], v11 offset:4480
    ds_read_b64_tr_b16 v[82:83], v11 offset:5376
    ds_read_b64_tr_b16 v[84:85], v11 offset:6272
    ds_read_b64_tr_b16 v[86:87], v11 offset:7168
    ds_read_b64_tr_b16 v[88:89], v11 offset:8064
    ds_read_b64_tr_b16 v[90:91], v11 offset:8960
    ds_read_b64_tr_b16 v[92:93], v11 offset:9856
    ds_read_b64_tr_b16 v[94:95], v11 offset:10752
    ds_read_b64_tr_b16 v[96:97], v11 offset:11648
    ds_read_b64_tr_b16 v[98:99], v11 offset:12544
    ds_read_b64_tr_b16 v[100:101], v11 offset:13440
    ds_read_b64_tr_b16 v[102:103], v11 offset:14336
    s_waitcnt lgkmcnt(15)
    v_mfma_f32_16x16x32_bf16 v[28:31], v[70:73], v[36:39], 0
    s_waitcnt lgkmcnt(13)
    s_nop 6
    v_mfma_f32_16x16x32_bf16 v[28:31], v[74:77], v[40:43], v[28:31]
    s_waitcnt lgkmcnt(11)
    s_nop 6
    v_mfma_f32_16x16x32_bf16 v[28:31], v[78:81], v[44:47], v[28:31]
    s_waitcnt lgkmcnt(9)
    s_nop 6
    v_mfma_f32_16x16x32_bf16 v[28:31], v[82:85], v[48:51], v[28:31]
    s_waitcnt lgkmcnt(7)
    s_nop 6
    v_mfma_f32_16x16x32_bf16 v[28:31], v[86:89], v[52:55], v[28:31]
    s_waitcnt lgkmcnt(5)
    s_nop 6
    v_mfma_f32_16x16x32_bf16 v[28:31], v[90:93], v[56:59], v[28:31]
    s_waitcnt lgkmcnt(3)
    s_nop 6
    v_mfma_f32_16x16x32_bf16 v[28:31], v[94:97], v[60:63], v[28:31]
    s_waitcnt lgkmcnt(1)
    s_nop 6
    v_mfma_f32_16x16x32_bf16 v[28:31], v[98:101], v[64:67], v[28:31]
    s_waitcnt lgkmcnt(0)
    s_nop 6
    v_mfma_f32_16x16x16_bf16 v[28:31], v[102:103], v[68:69], v[28:31]
    ds_read_b64_tr_b16 v[70:71], v11 offset:32
    ds_read_b64_tr_b16 v[72:73], v11 offset:928
    ds_read_b64_tr_b16 v[74:75], v11 offset:1824
    ds_read_b64_tr_b16 v[76:77], v11 offset:2720
    ds_read_b64_tr_b16 v[78:79], v11 offset:3616
    ds_read_b64_tr_b16 v[80:81], v11 offset:4512
    ds_read_b64_tr_b16 v[82:83], v11 offset:5408
    ds_read_b64_tr_b16 v[84:85], v11 offset:6304
    ds_read_b64_tr_b16 v[86:87], v11 offset:7200
    ds_read_b64_tr_b16 v[88:89], v11 offset:8096
    ds_read_b64_tr_b16 v[90:91], v11 offset:8992
    ds_read_b64_tr_b16 v[92:93], v11 offset:9888
    ds_read_b64_tr_b16 v[94:95], v11 offset:10784
    ds_read_b64_tr_b16 v[96:97], v11 offset:11680
    ds_read_b64_tr_b16 v[98:99], v11 offset:12576
    ds_read_b64_tr_b16 v[100:101], v11 offset:13472
    ds_read_b64_tr_b16 v[102:103], v11 offset:14368
    s_waitcnt lgkmcnt(15)
    v_mfma_f32_16x16x32_bf16 v[32:35], v[70:73], v[36:39], 0
    s_waitcnt lgkmcnt(13)
    s_nop 6
    v_mfma_f32_16x16x32_bf16 v[32:35], v[74:77], v[40:43], v[32:35]
    s_waitcnt lgkmcnt(11)
    s_nop 6
    v_mfma_f32_16x16x32_bf16 v[32:35], v[78:81], v[44:47], v[32:35]
    s_waitcnt lgkmcnt(9)
    s_nop 6
    v_mfma_f32_16x16x32_bf16 v[32:35], v[82:85], v[48:51], v[32:35]
    s_waitcnt lgkmcnt(7)
    s_nop 6
    v_mfma_f32_16x16x32_bf16 v[32:35], v[86:89], v[52:55], v[32:35]
    s_waitcnt lgkmcnt(5)
    s_nop 6
    v_mfma_f32_16x16x32_bf16 v[32:35], v[90:93], v[56:59], v[32:35]
    s_waitcnt lgkmcnt(3)
    s_nop 6
    v_mfma_f32_16x16x32_bf16 v[32:35], v[94:97], v[60:63], v[32:35]
    s_waitcnt lgkmcnt(1)
    s_nop 6
    v_mfma_f32_16x16x32_bf16 v[32:35], v[98:101], v[64:67], v[32:35]
    s_waitcnt lgkmcnt(0)
    s_nop 6
    v_mfma_f32_16x16x16_bf16 v[32:35], v[102:103], v[68:69], v[32:35]
    s_lshl_b32 s40, s30, 7
    s_add_u32 s40, s40, s35
    v_add_u32 v4, s40, v2
    s_movk_i32 s41, 896
    v_mul_lo_u32 v4, v4, s41
    v_lshl_add_u32 v4, v3, 3, v4
    s_mul_i32 s42, s29, 56
    s_add_u32 s42, s42, 5537792
    v_mul_f32 v28, v28, v8
    v_mul_f32 v29, v29, v8
    v_mul_f32 v30, v30, v8
    v_mul_f32 v31, v31, v8
    v_mul_f32 v32, v32, v8
    v_mul_f32 v33, v33, v8
    v_mul_f32 v34, v34, v8
    v_mul_f32 v35, v35, v8
    v_cvt_pk_bf16_f32 v12, v28, v29
    v_cvt_pk_bf16_f32 v13, v30, v31
    v_cvt_pk_bf16_f32 v14, v32, v33
    v_cvt_pk_bf16_f32 v15, v34, v35
    buffer_store_dwordx2 v[12:13], v4, s[8:11], s42 offen
    v_cmp_gt_u32 vcc, 48, v1
    s_and_saveexec_b64 s[44:45], vcc
    buffer_store_dwordx2 v[14:15], v4, s[8:11], s42 offen offset:32
    s_mov_b64 exec, s[44:45]
    s_endpgm
k2_ffn:
    s_sub_u32 s29, s2, 256
    s_cmp_ge_u32 s29, 112
    s_cbranch_scc1 k2_done
    s_load_dwordx2 s[4:5], s[0:1], 80
    s_load_dwordx2 s[6:7], s[0:1], 0
    s_load_dwordx4 s[12:15], s[0:1], 40
    v_lshlrev_b32 v4, 4, v0
    v_mov_b32 v5, 36864
    s_waitcnt lgkmcnt(0)
    s_mov_b32 s8, s4
    s_mov_b32 s9, s5
    s_mov_b32 s10, 0x70b000
    s_mov_b32 s11, 0x00020000
    s_mov_b32 s16, s6
    s_mov_b32 s17, s7
    s_mov_b32 s18, 0x1c0000
    s_mov_b32 s19, 0x00020000
    s_mov_b32 s20, s12
    s_mov_b32 s21, s13
    s_mov_b32 s22, 0x188000
    s_mov_b32 s23, 0x00020000
    s_mov_b32 s24, s14
    s_mov_b32 s25, s15
    s_mov_b32 s26, 0x188000
    s_mov_b32 s27, 0x00020000
    s_mov_b32 s30, 5521408
    buffer_load_dwordx4 v[16:19], v4, s[8:11], s30 offen
    v_lshrrev_b32 v8, 1, v0
    s_movk_i32 s33, 3584
    v_mul_lo_u32 v9, v8, s33
    v_and_b32 v10, 1, v0
    v_lshl_add_u32 v9, v10, 4, v9
    s_lshl_b32 s34, s29, 5
    s_add_u32 s35, s34, 0
    buffer_load_dwordx4 v[96:99], v9, s[20:23], s35 offen
    buffer_load_dwordx4 v[100:103], v9, s[24:27], s35 offen
    s_add_u32 s35, s34, 917504
    buffer_load_dwordx4 v[104:107], v9, s[20:23], s35 offen
    buffer_load_dwordx4 v[108:111], v9, s[24:27], s35 offen
    v_lshlrev_b32 v11, 2, v0
    s_waitcnt vmcnt(4)
    v_ashrrev_i32 v9, 31, v16
    v_or_b32 v9, 0x80000000, v9
    v_xor_b32 v9, v9, v16
    v_and_b32 v9, 0xffff0000, v9
    v_sub_u32 v12, 65535, v11
    v_or_b32 v20, v9, v12
    v_ashrrev_i32 v9, 31, v17
    v_or_b32 v9, 0x80000000, v9
    v_xor_b32 v9, v9, v17
    v_and_b32 v9, 0xffff0000, v9
    v_sub_u32 v12, 65534, v11
    v_or_b32 v21, v9, v12
    v_ashrrev_i32 v9, 31, v18
    v_or_b32 v9, 0x80000000, v9
    v_xor_b32 v9, v9, v18
    v_and_b32 v9, 0xffff0000, v9
    v_sub_u32 v12, 65533, v11
    v_or_b32 v22, v9, v12
    v_ashrrev_i32 v9, 31, v19
    v_or_b32 v9, 0x80000000, v9
    v_xor_b32 v9, v9, v19
    v_and_b32 v9, 0xffff0000, v9
    v_sub_u32 v12, 65532, v11
    v_or_b32 v23, v9, v12
    v_max_u32 v14, v20, v21
    v_min_u32 v15, v20, v21
    v_min_u32 v12, v14, v22
    v_max_u32 v14, v14, v22
    v_max_u32 v15, v15, v12
    v_min_u32 v12, v14, v23
    v_max_u32 v14, v14, v23
    v_max_u32 v15, v15, v12
    v_and_b32 v13, 63, v0
    v_xor_b32 v12, 1, v13
    v_lshlrev_b32 v12, 2, v12
    ds_bpermute_b32 v20, v12, v14
    ds_bpermute_b32 v21, v12, v15
    s_waitcnt lgkmcnt(1)
    v_min_u32 v22, v14, v20
    v_max_u32 v14, v14, v20
    s_waitcnt lgkmcnt(0)
    v_max_u32 v15, v15, v21
    v_max_u32 v15, v15, v22
    v_xor_b32 v12, 2, v13
    v_lshlrev_b32 v12, 2, v12
    ds_bpermute_b32 v20, v12, v14
    ds_bpermute_b32 v21, v12, v15
    s_waitcnt lgkmcnt(1)
    v_min_u32 v22, v14, v20
    v_max_u32 v14, v14, v20
    s_waitcnt lgkmcnt(0)
    v_max_u32 v15, v15, v21
    v_max_u32 v15, v15, v22
    v_xor_b32 v12, 4, v13
    v_lshlrev_b32 v12, 2, v12
    ds_bpermute_b32 v20, v12, v14
    ds_bpermute_b32 v21, v12, v15
    s_waitcnt lgkmcnt(1)
    v_min_u32 v22, v14, v20
    v_max_u32 v14, v14, v20
    s_waitcnt lgkmcnt(0)
    v_max_u32 v15, v15, v21
    v_max_u32 v15, v15, v22
    v_xor_b32 v12, 8, v13
    v_lshlrev_b32 v12, 2, v12
    ds_bpermute_b32 v20, v12, v14
    ds_bpermute_b32 v21, v12, v15
    s_waitcnt lgkmcnt(1)
    v_min_u32 v22, v14, v20
    v_max_u32 v14, v14, v20
    s_waitcnt lgkmcnt(0)
    v_max_u32 v15, v15, v21
    v_max_u32 v15, v15, v22
    v_xor_b32 v12, 16, v13
    v_lshlrev_b32 v12, 2, v12
    ds_bpermute_b32 v20, v12, v14
    ds_bpermute_b32 v21, v12, v15
    s_waitcnt lgkmcnt(1)
    v_min_u32 v22, v14, v20
    v_max_u32 v14, v14, v20
    s_waitcnt lgkmcnt(0)
    v_max_u32 v15, v15, v21
    v_max_u32 v15, v15, v22
    v_xor_b32 v12, 32, v13
    v_lshlrev_b32 v12, 2, v12
    ds_bpermute_b32 v20, v12, v14
    ds_bpermute_b32 v21, v12, v15
    s_waitcnt lgkmcnt(1)
    v_min_u32 v22, v14, v20
    v_max_u32 v14, v14, v20
    s_waitcnt lgkmcnt(0)
    v_max_u32 v15, v15, v21
    v_max_u32 v15, v15, v22
    v_lshrrev_b32 v12, 6, v0
    v_lshl_add_u32 v12, v12, 3, v5
    ds_write_b64 v12, v[14:15]
    s_waitcnt lgkmcnt(0)
    s_barrier
    ds_read_b128 v[16:19], v5 offset:0
    ds_read_b128 v[20:23], v5 offset:16
    ds_read_b128 v[24:27], v5 offset:32
    ds_read_b128 v[28:31], v5 offset:48
    s_waitcnt lgkmcnt(3)
    v_min_u32 v12, v16, v18
    v_max_u32 v16, v16, v18
    v_max_u32 v17, v17, v19
    v_max_u32 v17, v17, v12
    s_waitcnt lgkmcnt(2)
    v_min_u32 v12, v16, v20
    v_max_u32 v16, v16, v20
    v_max_u32 v17, v17, v21
    v_max_u32 v17, v17, v12
    v_min_u32 v12, v16, v22
    v_max_u32 v16, v16, v22
    v_max_u32 v17, v17, v23
    v_max_u32 v17, v17, v12
    s_waitcnt lgkmcnt(1)
    v_min_u32 v12, v16, v24
    v_max_u32 v16, v16, v24
    v_max_u32 v17, v17, v25
    v_max_u32 v17, v17, v12
    v_min_u32 v12, v16, v26
    v_max_u32 v16, v16, v26
    v_max_u32 v17, v17, v27
    v_max_u32 v17, v17, v12
    s_waitcnt lgkmcnt(0)
    v_min_u32 v12, v16, v28
    v_max_u32 v16, v16, v28
    v_max_u32 v17, v17, v29
    v_max_u32 v17, v17, v12
    v_min_u32 v12, v16, v30
    v_max_u32 v16, v16, v30
    v_max_u32 v17, v17, v31
    v_max_u32 v17, v17, v12
    v_and_b32 v12, 0xffff, v16
    v_sub_u32 v12, 0xffff, v12
    v_and_b32 v13, 0xffff, v17
    v_sub_u32 v13, 0xffff, v13
    s_mov_b32 s31, 5505024
    v_lshlrev_b32 v14, 3, v12
    v_lshlrev_b32 v15, 3, v13
    buffer_load_dwordx2 v[24:25], v14, s[8:11], s31 offen
    buffer_load_dwordx2 v[26:27], v15, s[8:11], s31 offen
    v_lshlrev_b32 v14, 2, v12
    v_lshlrev_b32 v15, 2, v13
    buffer_load_dword v28, v14, s[8:11], s30 offen
    buffer_load_dword v29, v15, s[8:11], s30 offen
    s_movk_i32 s32, 896
    v_mul_lo_u32 v14, v12, s32
    v_lshl_add_u32 v14, v8, 1, v14
    v_mul_lo_u32 v15, v13, s32
    v_lshl_add_u32 v15, v8, 1, v15
    buffer_load_ushort v16, v14, s[16:19], 0 offen offset:0
    buffer_load_ushort v18, v15, s[16:19], 0 offen offset:0
    buffer_load_ushort v17, v14, s[16:19], 0 offen offset:512
    buffer_load_ushort v19, v15, s[16:19], 0 offen offset:512
    v_lshlrev_b32 v30, 5, v8
    v_lshl_add_u32 v30, v10, 4, v30
    s_waitcnt vmcnt(11)
    ds_write_b128 v30, v[96:99] offset:0
    s_waitcnt vmcnt(10)
    ds_write_b128 v30, v[100:103] offset:16384
    s_waitcnt vmcnt(9)
    ds_write_b128 v30, v[104:107] offset:8192
    s_waitcnt vmcnt(8)
    ds_write_b128 v30, v[108:111] offset:24576
    s_waitcnt vmcnt(3)
    v_lshlrev_b32 v16, 16, v16
    v_sub_f32 v16, v16, v24
    v_cvt_pk_bf16_f32 v16, v16, v16
    v_lshlrev_b32 v16, 16, v16
    v_mul_f32 v16, v16, v25
    v_cvt_pk_bf16_f32 v16, v16, v16
    s_waitcnt vmcnt(2)
    v_lshlrev_b32 v18, 16, v18
    v_sub_f32 v18, v18, v26
    v_cvt_pk_bf16_f32 v18, v18, v18
    v_lshlrev_b32 v18, 16, v18
    v_mul_f32 v18, v18, v27
    v_cvt_pk_bf16_f32 v18, v18, v18
    s_waitcnt vmcnt(1)
    v_lshlrev_b32 v17, 16, v17
    v_sub_f32 v17, v17, v24
    v_cvt_pk_bf16_f32 v17, v17, v17
    v_lshlrev_b32 v17, 16, v17
    v_mul_f32 v17, v17, v25
    v_cvt_pk_bf16_f32 v17, v17, v17
    s_waitcnt vmcnt(0)
    v_lshlrev_b32 v19, 16, v19
    v_sub_f32 v19, v19, v26
    v_cvt_pk_bf16_f32 v19, v19, v19
    v_lshlrev_b32 v19, 16, v19
    v_mul_f32 v19, v19, v27
    v_cvt_pk_bf16_f32 v19, v19, v19
    v_lshlrev_b32 v31, 1, v8
    v_add_u32 v31, 32768, v31
    ds_write_b16 v31, v16 offset:0
    ds_write_b16 v31, v18 offset:1024
    ds_write_b16 v31, v17 offset:512
    ds_write_b16 v31, v19 offset:1536
    s_waitcnt lgkmcnt(0)
    s_barrier
    v_lshrrev_b32 v7, 6, v0
    s_nop 0
    v_readfirstlane_b32 s28, v7
    s_and_b32 s40, s28, 1
    s_lshr_b32 s41, s28, 1
    v_and_b32 v21, 15, v0
    v_bfe_u32 v22, v0, 4, 2
    v_bfe_u32 v23, v0, 2, 4
    v_lshlrev_b32 v23, 5, v23
    v_and_b32 v24, 3, v0
    v_lshl_add_u32 v23, v24, 3, v23
    s_lshl_b32 s42, s40, 14
    s_lshl_b32 s43, s41, 10
    s_add_u32 s42, s42, s43
    v_add_u32 v23, s42, v23
    v_lshlrev_b32 v25, 10, v21
    v_lshl_add_u32 v25, v22, 3, v25
    s_lshl_b32 s43, s41, 6
    s_add_u32 s43, s43, 32768
    v_add_u32 v25, s43, v25
    v_mov_b32 v64, 0
    v_mov_b32 v65, 0
    v_mov_b32 v66, 0
    v_mov_b32 v67, 0
    v_mov_b32 v68, 0
    v_mov_b32 v69, 0
    v_mov_b32 v70, 0
    v_mov_b32 v71, 0
    v_mov_b32 v72, 0
    v_mov_b32 v73, 0
    v_mov_b32 v74, 0
    v_mov_b32 v75, 0
    v_mov_b32 v76, 0
    v_mov_b32 v77, 0
    v_mov_b32 v78, 0
    v_mov_b32 v79, 0
    v_cmp_gt_u32 vcc, 2, v21
    s_and_saveexec_b64 s[36:37], vcc
    ds_read_b64 v[64:65], v25 offset:0
    ds_read_b64 v[66:67], v25 offset:32
    ds_read_b64 v[68:69], v25 offset:256
    ds_read_b64 v[70:71], v25 offset:288
    ds_read_b64 v[72:73], v25 offset:512
    ds_read_b64 v[74:75], v25 offset:544
    ds_read_b64 v[76:77], v25 offset:768
    ds_read_b64 v[78:79], v25 offset:800
    s_mov_b64 exec, s[36:37]
    ds_read_b64_tr_b16 v[80:81], v23 offset:0
    ds_read_b64_tr_b16 v[82:83], v23 offset:512
    ds_read_b64_tr_b16 v[84:85], v23 offset:4096
    ds_read_b64_tr_b16 v[86:87], v23 offset:4608
    ds_read_b64_tr_b16 v[88:89], v23 offset:8192
    ds_read_b64_tr_b16 v[90:91], v23 offset:8704
    ds_read_b64_tr_b16 v[92:93], v23 offset:12288
    ds_read_b64_tr_b16 v[94:95], v23 offset:12800
    s_waitcnt lgkmcnt(6)
    v_mfma_f32_16x16x32_bf16 v[96:99], v[80:83], v[64:67], 0
    s_waitcnt lgkmcnt(4)
    s_nop 6
    v_mfma_f32_16x16x32_bf16 v[96:99], v[84:87], v[68:71], v[96:99]
    s_waitcnt lgkmcnt(2)
    s_nop 6
    v_mfma_f32_16x16x32_bf16 v[96:99], v[88:91], v[72:75], v[96:99]
    s_waitcnt lgkmcnt(0)
    s_nop 6
    v_mfma_f32_16x16x32_bf16 v[96:99], v[92:95], v[76:79], v[96:99]
    v_lshlrev_b32 v26, 6, v21
    v_lshl_add_u32 v26, v22, 4, v26
    s_lshl_b32 s43, s28, 7
    s_add_u32 s43, s43, 34816
    v_add_u32 v26, s43, v26
    s_and_saveexec_b64 s[36:37], vcc
    s_nop 1
    ds_write_b128 v26, v[96:99]
    s_mov_b64 exec, s[36:37]
    s_waitcnt lgkmcnt(0)
    s_barrier
    v_cmp_gt_u32 vcc, 32, v0
    s_and_saveexec_b64 s[36:37], vcc
    s_nop 15
    s_nop 3
    s_cbranch_execz k2_f1_skip2
    v_lshrrev_b32 v17, 4, v0
    v_lshlrev_b32 v18, 2, v0
    v_add_u32 v18, 34816, v18
    ds_read_b32 v64, v18 offset:0
    ds_read_b32 v72, v18 offset:128
    ds_read_b32 v65, v18 offset:256
    ds_read_b32 v73, v18 offset:384
    ds_read_b32 v66, v18 offset:512
    ds_read_b32 v74, v18 offset:640
    ds_read_b32 v67, v18 offset:768
    ds_read_b32 v75, v18 offset:896
    s_waitcnt lgkmcnt(5)
    v_add_f32 v20, v64, v65
    s_waitcnt lgkmcnt(4)
    v_add_f32 v21, v72, v73
    s_waitcnt lgkmcnt(3)
    v_add_f32 v20, v20, v66
    s_waitcnt lgkmcnt(2)
    v_add_f32 v21, v21, v74
    s_waitcnt lgkmcnt(1)
    v_add_f32 v20, v20, v67
    s_waitcnt lgkmcnt(0)
    v_add_f32 v21, v21, v75
    v_cvt_pk_bf16_f32 v20, v20, v20
    v_lshlrev_b32 v20, 16, v20
    v_cvt_pk_bf16_f32 v21, v21, v21
    v_lshlrev_b32 v21, 16, v21
    v_mul_f32 v22, 0xbfb8aa3b, v20
    v_exp_f32 v22, v22
    s_nop 0
    v_add_f32 v22, 1.0, v22
    v_rcp_f32 v22, v22
    s_nop 0
    v_mul_f32 v22, v22, v20
    v_cvt_pk_bf16_f32 v22, v22, v22
    v_lshlrev_b32 v22, 16, v22
    v_mul_f32 v22, v22, v21
    v_cvt_pk_bf16_f32 v22, v22, v22
    v_mul_u32_u24 v16, 1792, v17
    v_and_b32 v17, 15, v0
    v_add_u32 v16, v16, v17
    s_lshl_b32 s38, s29, 4
    v_add_u32 v16, s38, v16
    v_lshlrev_b32 v16, 1, v16
    s_mov_b32 s39, 7372800
    buffer_store_short v22, v16, s[8:11], s39 offen
    s_waitcnt vmcnt(0)
k2_f1_skip2:
    s_mov_b64 exec, s[36:37]
    s_cmp_lg_u32 s29, 0
    s_cbranch_scc1 k2_done
    v_mul_f32 v16, 0xbfb8aa3b, v28
    v_exp_f32 v16, v16
    s_nop 0
    v_add_f32 v16, 1.0, v16
    v_rcp_f32 v16, v16
    s_nop 0
    v_cvt_pk_bf16_f32 v28, v16, v16
    v_lshlrev_b32 v28, 16, v28
    v_mul_f32 v16, 0xbfb8aa3b, v29
    v_exp_f32 v16, v16
    s_nop 0
    v_add_f32 v16, 1.0, v16
    v_rcp_f32 v16, v16
    s_nop 0
    v_cvt_pk_bf16_f32 v29, v16, v16
    v_lshlrev_b32 v29, 16, v29
    v_mov_b32 v16, v12
    v_mov_b32 v17, v13
    v_mov_b32 v18, v28
    v_mov_b32 v19, v29
    v_mov_b32 v20, 7380992
    v_cmp_eq_u32 vcc, 0, v0
    s_and_saveexec_b64 s[36:37], vcc
    buffer_store_dwordx4 v[16:19], v20, s[8:11], 0 offen
    s_waitcnt vmcnt(0)
k2_done:
    s_endpgm
.section .rodata,"a"
.p2align 6
.amdhsa_kernel k2_kernel
  .amdhsa_next_free_vgpr 128
  .amdhsa_next_free_sgpr 96
  .amdhsa_accum_offset 128
  .amdhsa_group_segment_fixed_size 0
  .amdhsa_kernarg_size 88
  .amdhsa_user_sgpr_count 2
  .amdhsa_user_sgpr_kernarg_segment_ptr 1
  .amdhsa_system_sgpr_workgroup_id_x 1
.end_amdhsa_kernel
.text
.globl k3_kernel
.p2align 8
.type k3_kernel,@function
k3_kernel:
    s_cmp_ge_u32 s2, 224
    s_cbranch_scc1 k3_ffn
    s_load_dwordx2 s[36:37], s[0:1], 80
    s_load_dwordx2 s[38:39], s[0:1], 16
    s_load_dwordx2 s[8:9], s[0:1], 0
    s_load_dwordx2 s[10:11], s[0:1], 64
    s_and_b32 s3, s2, 7
    s_lshr_b32 s4, s2, 3
    s_mul_i32 s5, s4, 37
    s_lshr_b32 s5, s5, 8
    s_mul_i32 s6, s5, 7
    s_sub_u32 s2, s4, s6
    s_lshl_b32 s3, s3, 2
    s_add_u32 s3, s3, s5
    v_and_b32 v1, 63, v0
    v_and_b32 v2, 15, v0
    v_bfe_u32 v3, v0, 4, 2
    v_lshrrev_b32 v5, 6, v0
    s_nop 0
    v_readfirstlane_b32 s28, v5
    s_waitcnt lgkmcnt(0)
    s_mov_b32 s12, s36
    s_mov_b32 s13, s37
    s_mov_b32 s14, 0x70b000
    s_mov_b32 s15, 0x00020000
    s_mov_b32 s16, s38
    s_mov_b32 s17, s39
    s_mov_b32 s18, 0x62000
    s_mov_b32 s19, 0x00020000
    s_mov_b32 s20, s8
    s_mov_b32 s21, s9
    s_mov_b32 s22, 0x1c0000
    s_mov_b32 s23, 0x00020000
    s_mov_b32 s24, s10
    s_mov_b32 s25, s11
    s_mov_b32 s26, 0x1c0000
    s_mov_b32 s27, 0x00020000
    s_add_u32 s50, s36, 7380992
    s_addc_u32 s51, s37, 0
    s_load_dwordx2 s[40:41], s[50:51], 0
    v_lshrrev_b32 v7, 3, v0
    v_and_b32 v8, 7, v0
    v_mul_u32_u24 v9, 896, v7
    v_lshl_add_u32 v9, v8, 4, v9
    s_lshl_b32 s33, s2, 7
    s_add_u32 s34, s33, 0
    buffer_load_dwordx4 v[72:75], v9, s[16:19], s34 offen
    s_add_u32 s34, s33, 28672
    buffer_load_dwordx4 v[76:79], v9, s[16:19], s34 offen
    s_add_u32 s34, s33, 57344
    buffer_load_dwordx4 v[80:83], v9, s[16:19], s34 offen
    s_add_u32 s34, s33, 86016
    buffer_load_dwordx4 v[84:87], v9, s[16:19], s34 offen
    s_add_u32 s34, s33, 114688
    buffer_load_dwordx4 v[88:91], v9, s[16:19], s34 offen
    s_add_u32 s34, s33, 143360
    buffer_load_dwordx4 v[92:95], v9, s[16:19], s34 offen
    s_add_u32 s34, s33, 172032
    buffer_load_dwordx4 v[96:99], v9, s[16:19], s34 offen
    s_add_u32 s34, s33, 200704
    buffer_load_dwordx4 v[100:103], v9, s[16:19], s34 offen
    s_add_u32 s34, s33, 229376
    buffer_load_dwordx4 v[104:107], v9, s[16:19], s34 offen
    s_add_u32 s34, s33, 258048
    buffer_load_dwordx4 v[108:111], v9, s[16:19], s34 offen
    s_add_u32 s34, s33, 286720
    buffer_load_dwordx4 v[112:115], v9, s[16:19], s34 offen
    s_add_u32 s34, s33, 315392
    buffer_load_dwordx4 v[116:119], v9, s[16:19], s34 offen
    s_add_u32 s34, s33, 344064
    buffer_load_dwordx4 v[120:123], v9, s[16:19], s34 offen
    s_add_u32 s34, s33, 372736
    buffer_load_dwordx4 v[124:127], v9, s[16:19], s34 offen
    s_lshl_b32 s29, s3, 6
    s_lshl_b32 s30, s28, 4
    s_add_u32 s29, s29, s30
    v_add_u32 v6, s29, v2
    s_movk_i32 s31, 896
    v_mul_lo_u32 v4, v6, s31
    v_lshl_add_u32 v4, v3, 3, v4
    s_mov_b32 s32, 5537792
    buffer_load_dwordx2 v[16:17], v4, s[12:15], s32 offen offset:0
    buffer_load_dwordx2 v[18:19], v4, s[12:15], s32 offen offset:32
    buffer_load_dwordx2 v[20:21], v4, s[12:15], s32 offen offset:64
    buffer_load_dwordx2 v[22:23], v4, s[12:15], s32 offen offset:96
    buffer_load_dwordx2 v[24:25], v4, s[12:15], s32 offen offset:128
    buffer_load_dwordx2 v[26:27], v4, s[12:15], s32 offen offset:160
    buffer_load_dwordx2 v[28:29], v4, s[12:15], s32 offen offset:192
    buffer_load_dwordx2 v[30:31], v4, s[12:15], s32 offen offset:224
    buffer_load_dwordx2 v[32:33], v4, s[12:15], s32 offen offset:256
    buffer_load_dwordx2 v[34:35], v4, s[12:15], s32 offen offset:288
    buffer_load_dwordx2 v[36:37], v4, s[12:15], s32 offen offset:320
    buffer_load_dwordx2 v[38:39], v4, s[12:15], s32 offen offset:352
    buffer_load_dwordx2 v[40:41], v4, s[12:15], s32 offen offset:384
    buffer_load_dwordx2 v[42:43], v4, s[12:15], s32 offen offset:416
    buffer_load_dwordx2 v[44:45], v4, s[12:15], s32 offen offset:448
    buffer_load_dwordx2 v[46:47], v4, s[12:15], s32 offen offset:480
    buffer_load_dwordx2 v[48:49], v4, s[12:15], s32 offen offset:512
    buffer_load_dwordx2 v[50:51], v4, s[12:15], s32 offen offset:544
    buffer_load_dwordx2 v[52:53], v4, s[12:15], s32 offen offset:576
    buffer_load_dwordx2 v[54:55], v4, s[12:15], s32 offen offset:608
    buffer_load_dwordx2 v[56:57], v4, s[12:15], s32 offen offset:640
    buffer_load_dwordx2 v[58:59], v4, s[12:15], s32 offen offset:672
    buffer_load_dwordx2 v[60:61], v4, s[12:15], s32 offen offset:704
    buffer_load_dwordx2 v[62:63], v4, s[12:15], s32 offen offset:736
    buffer_load_dwordx2 v[64:65], v4, s[12:15], s32 offen offset:768
    buffer_load_dwordx2 v[66:67], v4, s[12:15], s32 offen offset:800
    buffer_load_dwordx2 v[68:69], v4, s[12:15], s32 offen offset:832
    buffer_load_dwordx2 v[70:71], v4, s[12:15], s32 offen offset:864
    s_lshl_b32 s43, s2, 7
    v_add_u32 v10, s43, v4
    buffer_load_dwordx2 v[160:161], v10, s[20:23], 0 offen offset:0
    buffer_load_dwordx2 v[162:163], v10, s[20:23], 0 offen offset:32
    buffer_load_dwordx2 v[164:165], v10, s[20:23], 0 offen offset:64
    buffer_load_dwordx2 v[166:167], v10, s[20:23], 0 offen offset:96
    v_lshlrev_b32 v11, 3, v6
    s_mov_b32 s45, 5505024
    buffer_load_dwordx2 v[168:169], v11, s[12:15], s45 offen
    v_mul_u32_u24 v11, 160, v7
    v_lshl_add_u32 v11, v8, 4, v11
    v_add_u32 v12, 35840, v11
    s_waitcnt vmcnt(46)
    ds_write_b128 v11, v[72:75] offset:0
    s_waitcnt vmcnt(45)
    ds_write_b128 v11, v[76:79] offset:5120
    s_waitcnt vmcnt(44)
    ds_write_b128 v11, v[80:83] offset:10240
    s_waitcnt vmcnt(43)
    ds_write_b128 v11, v[84:87] offset:15360
    s_waitcnt vmcnt(42)
    ds_write_b128 v11, v[88:91] offset:20480
    s_waitcnt vmcnt(41)
    ds_write_b128 v11, v[92:95] offset:25600
    s_waitcnt vmcnt(40)
    ds_write_b128 v11, v[96:99] offset:30720
    s_waitcnt vmcnt(39)
    ds_write_b128 v12, v[100:103] offset:0
    s_waitcnt vmcnt(38)
    ds_write_b128 v12, v[104:107] offset:5120
    s_waitcnt vmcnt(37)
    ds_write_b128 v12, v[108:111] offset:10240
    s_waitcnt vmcnt(36)
    ds_write_b128 v12, v[112:115] offset:15360
    s_waitcnt vmcnt(35)
    ds_write_b128 v12, v[116:119] offset:20480
    s_waitcnt vmcnt(34)
    ds_write_b128 v12, v[120:123] offset:25600
    s_waitcnt vmcnt(33)
    ds_write_b128 v12, v[124:127] offset:30720
    v_bfe_u32 v5, v0, 2, 4
    v_mul_u32_u24 v5, 160, v5
    v_and_b32 v7, 3, v0
    v_lshl_add_u32 v5, v7, 3, v5
    v_add_u32 v13, 35840, v5
    v_mov_b32 v136, 0
    v_mov_b32 v137, 0
    v_mov_b32 v138, 0
    v_mov_b32 v139, 0
    v_mov_b32 v140, 0
    v_mov_b32 v141, 0
    v_mov_b32 v142, 0
    v_mov_b32 v143, 0
    v_mov_b32 v144, 0
    v_mov_b32 v145, 0
    v_mov_b32 v146, 0
    v_mov_b32 v147, 0
    v_mov_b32 v148, 0
    v_mov_b32 v149, 0
    v_mov_b32 v150, 0
    v_mov_b32 v151, 0
    s_waitcnt lgkmcnt(0)
    s_barrier
    ds_read_b64_tr_b16 v[72:73], v5 offset:0
    ds_read_b64_tr_b16 v[74:75], v5 offset:2560
    ds_read_b64_tr_b16 v[76:77], v5 offset:32
    ds_read_b64_tr_b16 v[78:79], v5 offset:2592
    ds_read_b64_tr_b16 v[80:81], v5 offset:64
    ds_read_b64_tr_b16 v[82:83], v5 offset:2624
    ds_read_b64_tr_b16 v[84:85], v5 offset:96
    ds_read_b64_tr_b16 v[86:87], v5 offset:2656
    ds_read_b64_tr_b16 v[88:89], v5 offset:5120
    ds_read_b64_tr_b16 v[90:91], v5 offset:7680
    ds_read_b64_tr_b16 v[92:93], v5 offset:5152
    ds_read_b64_tr_b16 v[94:95], v5 offset:7712
    ds_read_b64_tr_b16 v[96:97], v5 offset:5184
    ds_read_b64_tr_b16 v[98:99], v5 offset:7744
    ds_read_b64_tr_b16 v[100:101], v5 offset:5216
    ds_read_b64_tr_b16 v[102:103], v5 offset:7776
    ds_read_b64_tr_b16 v[104:105], v5 offset:10240
    ds_read_b64_tr_b16 v[106:107], v5 offset:12800
    ds_read_b64_tr_b16 v[108:109], v5 offset:10272
    ds_read_b64_tr_b16 v[110:111], v5 offset:12832
    ds_read_b64_tr_b16 v[112:113], v5 offset:10304
    ds_read_b64_tr_b16 v[114:115], v5 offset:12864
    ds_read_b64_tr_b16 v[116:117], v5 offset:10336
    ds_read_b64_tr_b16 v[118:119], v5 offset:12896
    ds_read_b64_tr_b16 v[120:121], v5 offset:15360
    ds_read_b64_tr_b16 v[122:123], v5 offset:17920
    ds_read_b64_tr_b16 v[124:125], v5 offset:15392
    ds_read_b64_tr_b16 v[126:127], v5 offset:17952
    ds_read_b64_tr_b16 v[128:129], v5 offset:15424
    ds_read_b64_tr_b16 v[130:131], v5 offset:17984
    ds_read_b64_tr_b16 v[132:133], v5 offset:15456
    ds_read_b64_tr_b16 v[134:135], v5 offset:18016
    s_waitcnt vmcnt(31) lgkmcnt(15)
    v_mfma_f32_16x16x32_bf16 v[136:139], v[72:75], v[16:19], v[136:139]
    v_mfma_f32_16x16x32_bf16 v[140:143], v[76:79], v[16:19], v[140:143]
    v_mfma_f32_16x16x32_bf16 v[144:147], v[80:83], v[16:19], v[144:147]
    v_mfma_f32_16x16x32_bf16 v[148:151], v[84:87], v[16:19], v[148:151]
    ds_read_b64_tr_b16 v[72:73], v5 offset:20480
    ds_read_b64_tr_b16 v[74:75], v5 offset:23040
    ds_read_b64_tr_b16 v[76:77], v5 offset:20512
    ds_read_b64_tr_b16 v[78:79], v5 offset:23072
    ds_read_b64_tr_b16 v[80:81], v5 offset:20544
    ds_read_b64_tr_b16 v[82:83], v5 offset:23104
    ds_read_b64_tr_b16 v[84:85], v5 offset:20576
    ds_read_b64_tr_b16 v[86:87], v5 offset:23136
    s_waitcnt vmcnt(29)
    v_mfma_f32_16x16x32_bf16 v[136:139], v[88:91], v[20:23], v[136:139]
    v_mfma_f32_16x16x32_bf16 v[140:143], v[92:95], v[20:23], v[140:143]
    v_mfma_f32_16x16x32_bf16 v[144:147], v[96:99], v[20:23], v[144:147]
    v_mfma_f32_16x16x32_bf16 v[148:151], v[100:103], v[20:23], v[148:151]
    ds_read_b64_tr_b16 v[88:89], v5 offset:25600
    ds_read_b64_tr_b16 v[90:91], v5 offset:28160
    ds_read_b64_tr_b16 v[92:93], v5 offset:25632
    ds_read_b64_tr_b16 v[94:95], v5 offset:28192
    ds_read_b64_tr_b16 v[96:97], v5 offset:25664
    ds_read_b64_tr_b16 v[98:99], v5 offset:28224
    ds_read_b64_tr_b16 v[100:101], v5 offset:25696
    ds_read_b64_tr_b16 v[102:103], v5 offset:28256
    s_waitcnt vmcnt(27) lgkmcnt(15)
    v_mfma_f32_16x16x32_bf16 v[136:139], v[104:107], v[24:27], v[136:139]
    v_mfma_f32_16x16x32_bf16 v[140:143], v[108:111], v[24:27], v[140:143]
    v_mfma_f32_16x16x32_bf16 v[144:147], v[112:115], v[24:27], v[144:147]
    v_mfma_f32_16x16x32_bf16 v[148:151], v[116:119], v[24:27], v[148:151]
    ds_read_b64_tr_b16 v[104:105], v5 offset:30720
    ds_read_b64_tr_b16 v[106:107], v5 offset:33280
    ds_read_b64_tr_b16 v[108:109], v5 offset:30752
    ds_read_b64_tr_b16 v[110:111], v5 offset:33312
    ds_read_b64_tr_b16 v[112:113], v5 offset:30784
    ds_read_b64_tr_b16 v[114:115], v5 offset:33344
    ds_read_b64_tr_b16 v[116:117], v5 offset:30816
    ds_read_b64_tr_b16 v[118:119], v5 offset:33376
    s_waitcnt vmcnt(25)
    v_mfma_f32_16x16x32_bf16 v[136:139], v[120:123], v[28:31], v[136:139]
    v_mfma_f32_16x16x32_bf16 v[140:143], v[124:127], v[28:31], v[140:143]
    v_mfma_f32_16x16x32_bf16 v[144:147], v[128:131], v[28:31], v[144:147]
    v_mfma_f32_16x16x32_bf16 v[148:151], v[132:135], v[28:31], v[148:151]
    ds_read_b64_tr_b16 v[120:121], v13 offset:0
    ds_read_b64_tr_b16 v[122:123], v13 offset:2560
    ds_read_b64_tr_b16 v[124:125], v13 offset:32
    ds_read_b64_tr_b16 v[126:127], v13 offset:2592
    ds_read_b64_tr_b16 v[128:129], v13 offset:64
    ds_read_b64_tr_b16 v[130:131], v13 offset:2624
    ds_read_b64_tr_b16 v[132:133], v13 offset:96
    ds_read_b64_tr_b16 v[134:135], v13 offset:2656
    s_waitcnt vmcnt(23) lgkmcnt(15)
    v_mfma_f32_16x16x32_bf16 v[136:139], v[72:75], v[32:35], v[136:139]
    v_mfma_f32_16x16x32_bf16 v[140:143], v[76:79], v[32:35], v[140:143]
    v_mfma_f32_16x16x32_bf16 v[144:147], v[80:83], v[32:35], v[144:147]
    v_mfma_f32_16x16x32_bf16 v[148:151], v[84:87], v[32:35], v[148:151]
    ds_read_b64_tr_b16 v[72:73], v13 offset:5120
    ds_read_b64_tr_b16 v[74:75], v13 offset:7680
    ds_read_b64_tr_b16 v[76:77], v13 offset:5152
    ds_read_b64_tr_b16 v[78:79], v13 offset:7712
    ds_read_b64_tr_b16 v[80:81], v13 offset:5184
    ds_read_b64_tr_b16 v[82:83], v13 offset:7744
    ds_read_b64_tr_b16 v[84:85], v13 offset:5216
    ds_read_b64_tr_b16 v[86:87], v13 offset:7776
    s_waitcnt vmcnt(21)
    v_mfma_f32_16x16x32_bf16 v[136:139], v[88:91], v[36:39], v[136:139]
    v_mfma_f32_16x16x32_bf16 v[140:143], v[92:95], v[36:39], v[140:143]
    v_mfma_f32_16x16x32_bf16 v[144:147], v[96:99], v[36:39], v[144:147]
    v_mfma_f32_16x16x32_bf16 v[148:151], v[100:103], v[36:39], v[148:151]
    ds_read_b64_tr_b16 v[88:89], v13 offset:10240
    ds_read_b64_tr_b16 v[90:91], v13 offset:12800
    ds_read_b64_tr_b16 v[92:93], v13 offset:10272
    ds_read_b64_tr_b16 v[94:95], v13 offset:12832
    ds_read_b64_tr_b16 v[96:97], v13 offset:10304
    ds_read_b64_tr_b16 v[98:99], v13 offset:12864
    ds_read_b64_tr_b16 v[100:101], v13 offset:10336
    ds_read_b64_tr_b16 v[102:103], v13 offset:12896
    s_waitcnt vmcnt(19) lgkmcnt(15)
    v_mfma_f32_16x16x32_bf16 v[136:139], v[104:107], v[40:43], v[136:139]
    v_mfma_f32_16x16x32_bf16 v[140:143], v[108:111], v[40:43], v[140:143]
    v_mfma_f32_16x16x32_bf16 v[144:147], v[112:115], v[40:43], v[144:147]
    v_mfma_f32_16x16x32_bf16 v[148:151], v[116:119], v[40:43], v[148:151]
    ds_read_b64_tr_b16 v[104:105], v13 offset:15360
    ds_read_b64_tr_b16 v[106:107], v13 offset:17920
    ds_read_b64_tr_b16 v[108:109], v13 offset:15392
    ds_read_b64_tr_b16 v[110:111], v13 offset:17952
    ds_read_b64_tr_b16 v[112:113], v13 offset:15424
    ds_read_b64_tr_b16 v[114:115], v13 offset:17984
    ds_read_b64_tr_b16 v[116:117], v13 offset:15456
    ds_read_b64_tr_b16 v[118:119], v13 offset:18016
    s_waitcnt vmcnt(17)
    v_mfma_f32_16x16x32_bf16 v[136:139], v[120:123], v[44:47], v[136:139]
    v_mfma_f32_16x16x32_bf16 v[140:143], v[124:127], v[44:47], v[140:143]
    v_mfma_f32_16x16x32_bf16 v[144:147], v[128:131], v[44:47], v[144:147]
    v_mfma_f32_16x16x32_bf16 v[148:151], v[132:135], v[44:47], v[148:151]
    ds_read_b64_tr_b16 v[120:121], v13 offset:20480
    ds_read_b64_tr_b16 v[122:123], v13 offset:23040
    ds_read_b64_tr_b16 v[124:125], v13 offset:20512
    ds_read_b64_tr_b16 v[126:127], v13 offset:23072
    ds_read_b64_tr_b16 v[128:129], v13 offset:20544
    ds_read_b64_tr_b16 v[130:131], v13 offset:23104
    ds_read_b64_tr_b16 v[132:133], v13 offset:20576
    ds_read_b64_tr_b16 v[134:135], v13 offset:23136
    s_waitcnt vmcnt(15) lgkmcnt(15)
    v_mfma_f32_16x16x32_bf16 v[136:139], v[72:75], v[48:51], v[136:139]
    v_mfma_f32_16x16x32_bf16 v[140:143], v[76:79], v[48:51], v[140:143]
    v_mfma_f32_16x16x32_bf16 v[144:147], v[80:83], v[48:51], v[144:147]
    v_mfma_f32_16x16x32_bf16 v[148:151], v[84:87], v[48:51], v[148:151]
    ds_read_b64_tr_b16 v[72:73], v13 offset:25600
    ds_read_b64_tr_b16 v[74:75], v13 offset:28160
    ds_read_b64_tr_b16 v[76:77], v13 offset:25632
    ds_read_b64_tr_b16 v[78:79], v13 offset:28192
    ds_read_b64_tr_b16 v[80:81], v13 offset:25664
    ds_read_b64_tr_b16 v[82:83], v13 offset:28224
    ds_read_b64_tr_b16 v[84:85], v13 offset:25696
    ds_read_b64_tr_b16 v[86:87], v13 offset:28256
    s_waitcnt vmcnt(13)
    v_mfma_f32_16x16x32_bf16 v[136:139], v[88:91], v[52:55], v[136:139]
    v_mfma_f32_16x16x32_bf16 v[140:143], v[92:95], v[52:55], v[140:143]
    v_mfma_f32_16x16x32_bf16 v[144:147], v[96:99], v[52:55], v[144:147]
    v_mfma_f32_16x16x32_bf16 v[148:151], v[100:103], v[52:55], v[148:151]
    ds_read_b64_tr_b16 v[88:89], v13 offset:30720
    ds_read_b64_tr_b16 v[90:91], v13 offset:33280
    ds_read_b64_tr_b16 v[92:93], v13 offset:30752
    ds_read_b64_tr_b16 v[94:95], v13 offset:33312
    ds_read_b64_tr_b16 v[96:97], v13 offset:30784
    ds_read_b64_tr_b16 v[98:99], v13 offset:33344
    ds_read_b64_tr_b16 v[100:101], v13 offset:30816
    ds_read_b64_tr_b16 v[102:103], v13 offset:33376
    s_waitcnt vmcnt(11) lgkmcnt(15)
    v_mfma_f32_16x16x32_bf16 v[136:139], v[104:107], v[56:59], v[136:139]
    v_mfma_f32_16x16x32_bf16 v[140:143], v[108:111], v[56:59], v[140:143]
    v_mfma_f32_16x16x32_bf16 v[144:147], v[112:115], v[56:59], v[144:147]
    v_mfma_f32_16x16x32_bf16 v[148:151], v[116:119], v[56:59], v[148:151]
    s_waitcnt vmcnt(9)
    s_nop 3
    v_mfma_f32_16x16x32_bf16 v[136:139], v[120:123], v[60:63], v[136:139]
    v_mfma_f32_16x16x32_bf16 v[140:143], v[124:127], v[60:63], v[140:143]
    v_mfma_f32_16x16x32_bf16 v[144:147], v[128:131], v[60:63], v[144:147]
    v_mfma_f32_16x16x32_bf16 v[148:151], v[132:135], v[60:63], v[148:151]
    s_waitcnt vmcnt(7) lgkmcnt(14)
    s_nop 3
    v_mfma_f32_16x16x32_bf16 v[136:139], v[72:75], v[64:67], v[136:139]
    s_waitcnt lgkmcnt(12)
    v_mfma_f32_16x16x32_bf16 v[140:143], v[76:79], v[64:67], v[140:143]
    s_waitcnt lgkmcnt(10)
    v_mfma_f32_16x16x32_bf16 v[144:147], v[80:83], v[64:67], v[144:147]
    s_waitcnt lgkmcnt(8)
    v_mfma_f32_16x16x32_bf16 v[148:151], v[84:87], v[64:67], v[148:151]
    s_waitcnt vmcnt(5) lgkmcnt(6)
    s_nop 0
    v_mfma_f32_16x16x32_bf16 v[136:139], v[88:91], v[68:71], v[136:139]
    s_waitcnt lgkmcnt(4)
    v_mfma_f32_16x16x32_bf16 v[140:143], v[92:95], v[68:71], v[140:143]
    s_waitcnt lgkmcnt(2)
    v_mfma_f32_16x16x32_bf16 v[144:147], v[96:99], v[68:71], v[144:147]
    s_waitcnt lgkmcnt(0)
    v_mfma_f32_16x16x32_bf16 v[148:151], v[100:103], v[68:71], v[148:151]
    v_cmp_ne_u32 vcc, s40, v6
    v_cmp_ne_u32 s[46:47], s41, v6
    s_and_b64 vcc, vcc, s[46:47]
    s_and_saveexec_b64 s[48:49], vcc
    s_waitcnt vmcnt(4)
    v_lshlrev_b32 v172, 16, v160
    v_and_b32 v173, 0xffff0000, v160
    v_lshlrev_b32 v174, 16, v161
    v_and_b32 v175, 0xffff0000, v161
    v_cvt_pk_bf16_f32 v136, v136, v136
    v_lshlrev_b32 v136, 16, v136
    v_add_f32 v136, v172, v136
    v_cvt_pk_bf16_f32 v136, v136, v136
    v_lshlrev_b32 v136, 16, v136
    s_waitcnt vmcnt(0)
    v_sub_f32 v180, v172, v168
    v_cvt_pk_bf16_f32 v180, v180, v180
    v_lshlrev_b32 v180, 16, v180
    v_mul_f32 v180, v180, v169
    v_cvt_pk_bf16_f32 v180, v180, v180
    v_lshlrev_b32 v180, 16, v180
    v_add_f32 v176, v136, v180
    v_cvt_pk_bf16_f32 v137, v137, v137
    v_lshlrev_b32 v137, 16, v137
    v_add_f32 v137, v173, v137
    v_cvt_pk_bf16_f32 v137, v137, v137
    v_lshlrev_b32 v137, 16, v137
    v_sub_f32 v180, v173, v168
    v_cvt_pk_bf16_f32 v180, v180, v180
    v_lshlrev_b32 v180, 16, v180
    v_mul_f32 v180, v180, v169
    v_cvt_pk_bf16_f32 v180, v180, v180
    v_lshlrev_b32 v180, 16, v180
    v_add_f32 v177, v137, v180
    v_cvt_pk_bf16_f32 v138, v138, v138
    v_lshlrev_b32 v138, 16, v138
    v_add_f32 v138, v174, v138
    v_cvt_pk_bf16_f32 v138, v138, v138
    v_lshlrev_b32 v138, 16, v138
    v_sub_f32 v180, v174, v168
    v_cvt_pk_bf16_f32 v180, v180, v180
    v_lshlrev_b32 v180, 16, v180
    v_mul_f32 v180, v180, v169
    v_cvt_pk_bf16_f32 v180, v180, v180
    v_lshlrev_b32 v180, 16, v180
    v_add_f32 v178, v138, v180
    v_cvt_pk_bf16_f32 v139, v139, v139
    v_lshlrev_b32 v139, 16, v139
    v_add_f32 v139, v175, v139
    v_cvt_pk_bf16_f32 v139, v139, v139
    v_lshlrev_b32 v139, 16, v139
    v_sub_f32 v180, v175, v168
    v_cvt_pk_bf16_f32 v180, v180, v180
    v_lshlrev_b32 v180, 16, v180
    v_mul_f32 v180, v180, v169
    v_cvt_pk_bf16_f32 v180, v180, v180
    v_lshlrev_b32 v180, 16, v180
    v_add_f32 v179, v139, v180
    v_cvt_pk_bf16_f32 v182, v176, v177
    v_cvt_pk_bf16_f32 v183, v178, v179
    buffer_store_dwordx2 v[182:183], v10, s[24:27], 0 offen offset:0
    v_lshlrev_b32 v172, 16, v162
    v_and_b32 v173, 0xffff0000, v162
    v_lshlrev_b32 v174, 16, v163
    v_and_b32 v175, 0xffff0000, v163
    v_cvt_pk_bf16_f32 v140, v140, v140
    v_lshlrev_b32 v140, 16, v140
    v_add_f32 v140, v172, v140
    v_cvt_pk_bf16_f32 v140, v140, v140
    v_lshlrev_b32 v140, 16, v140
    v_sub_f32 v180, v172, v168
    v_cvt_pk_bf16_f32 v180, v180, v180
    v_lshlrev_b32 v180, 16, v180
    v_mul_f32 v180, v180, v169
    v_cvt_pk_bf16_f32 v180, v180, v180
    v_lshlrev_b32 v180, 16, v180
    v_add_f32 v176, v140, v180
    v_cvt_pk_bf16_f32 v141, v141, v141
    v_lshlrev_b32 v141, 16, v141
    v_add_f32 v141, v173, v141
    v_cvt_pk_bf16_f32 v141, v141, v141
    v_lshlrev_b32 v141, 16, v141
    v_sub_f32 v180, v173, v168
    v_cvt_pk_bf16_f32 v180, v180, v180
    v_lshlrev_b32 v180, 16, v180
    v_mul_f32 v180, v180, v169
    v_cvt_pk_bf16_f32 v180, v180, v180
    v_lshlrev_b32 v180, 16, v180
    v_add_f32 v177, v141, v180
    v_cvt_pk_bf16_f32 v142, v142, v142
    v_lshlrev_b32 v142, 16, v142
    v_add_f32 v142, v174, v142
    v_cvt_pk_bf16_f32 v142, v142, v142
    v_lshlrev_b32 v142, 16, v142
    v_sub_f32 v180, v174, v168
    v_cvt_pk_bf16_f32 v180, v180, v180
    v_lshlrev_b32 v180, 16, v180
    v_mul_f32 v180, v180, v169
    v_cvt_pk_bf16_f32 v180, v180, v180
    v_lshlrev_b32 v180, 16, v180
    v_add_f32 v178, v142, v180
    v_cvt_pk_bf16_f32 v143, v143, v143
    v_lshlrev_b32 v143, 16, v143
    v_add_f32 v143, v175, v143
    v_cvt_pk_bf16_f32 v143, v143, v143
    v_lshlrev_b32 v143, 16, v143
    v_sub_f32 v180, v175, v168
    v_cvt_pk_bf16_f32 v180, v180, v180
    v_lshlrev_b32 v180, 16, v180
    v_mul_f32 v180, v180, v169
    v_cvt_pk_bf16_f32 v180, v180, v180
    v_lshlrev_b32 v180, 16, v180
    v_add_f32 v179, v143, v180
    v_cvt_pk_bf16_f32 v182, v176, v177
    v_cvt_pk_bf16_f32 v183, v178, v179
    buffer_store_dwordx2 v[182:183], v10, s[24:27], 0 offen offset:32
    v_lshlrev_b32 v172, 16, v164
    v_and_b32 v173, 0xffff0000, v164
    v_lshlrev_b32 v174, 16, v165
    v_and_b32 v175, 0xffff0000, v165
    v_cvt_pk_bf16_f32 v144, v144, v144
    v_lshlrev_b32 v144, 16, v144
    v_add_f32 v144, v172, v144
    v_cvt_pk_bf16_f32 v144, v144, v144
    v_lshlrev_b32 v144, 16, v144
    v_sub_f32 v180, v172, v168
    v_cvt_pk_bf16_f32 v180, v180, v180
    v_lshlrev_b32 v180, 16, v180
    v_mul_f32 v180, v180, v169
    v_cvt_pk_bf16_f32 v180, v180, v180
    v_lshlrev_b32 v180, 16, v180
    v_add_f32 v176, v144, v180
    v_cvt_pk_bf16_f32 v145, v145, v145
    v_lshlrev_b32 v145, 16, v145
    v_add_f32 v145, v173, v145
    v_cvt_pk_bf16_f32 v145, v145, v145
    v_lshlrev_b32 v145, 16, v145
    v_sub_f32 v180, v173, v168
    v_cvt_pk_bf16_f32 v180, v180, v180
    v_lshlrev_b32 v180, 16, v180
    v_mul_f32 v180, v180, v169
    v_cvt_pk_bf16_f32 v180, v180, v180
    v_lshlrev_b32 v180, 16, v180
    v_add_f32 v177, v145, v180
    v_cvt_pk_bf16_f32 v146, v146, v146
    v_lshlrev_b32 v146, 16, v146
    v_add_f32 v146, v174, v146
    v_cvt_pk_bf16_f32 v146, v146, v146
    v_lshlrev_b32 v146, 16, v146
    v_sub_f32 v180, v174, v168
    v_cvt_pk_bf16_f32 v180, v180, v180
    v_lshlrev_b32 v180, 16, v180
    v_mul_f32 v180, v180, v169
    v_cvt_pk_bf16_f32 v180, v180, v180
    v_lshlrev_b32 v180, 16, v180
    v_add_f32 v178, v146, v180
    v_cvt_pk_bf16_f32 v147, v147, v147
    v_lshlrev_b32 v147, 16, v147
    v_add_f32 v147, v175, v147
    v_cvt_pk_bf16_f32 v147, v147, v147
    v_lshlrev_b32 v147, 16, v147
    v_sub_f32 v180, v175, v168
    v_cvt_pk_bf16_f32 v180, v180, v180
    v_lshlrev_b32 v180, 16, v180
    v_mul_f32 v180, v180, v169
    v_cvt_pk_bf16_f32 v180, v180, v180
    v_lshlrev_b32 v180, 16, v180
    v_add_f32 v179, v147, v180
    v_cvt_pk_bf16_f32 v182, v176, v177
    v_cvt_pk_bf16_f32 v183, v178, v179
    buffer_store_dwordx2 v[182:183], v10, s[24:27], 0 offen offset:64
    v_lshlrev_b32 v172, 16, v166
    v_and_b32 v173, 0xffff0000, v166
    v_lshlrev_b32 v174, 16, v167
    v_and_b32 v175, 0xffff0000, v167
    v_cvt_pk_bf16_f32 v148, v148, v148
    v_lshlrev_b32 v148, 16, v148
    v_add_f32 v148, v172, v148
    v_cvt_pk_bf16_f32 v148, v148, v148
    v_lshlrev_b32 v148, 16, v148
    v_sub_f32 v180, v172, v168
    v_cvt_pk_bf16_f32 v180, v180, v180
    v_lshlrev_b32 v180, 16, v180
    v_mul_f32 v180, v180, v169
    v_cvt_pk_bf16_f32 v180, v180, v180
    v_lshlrev_b32 v180, 16, v180
    v_add_f32 v176, v148, v180
    v_cvt_pk_bf16_f32 v149, v149, v149
    v_lshlrev_b32 v149, 16, v149
    v_add_f32 v149, v173, v149
    v_cvt_pk_bf16_f32 v149, v149, v149
    v_lshlrev_b32 v149, 16, v149
    v_sub_f32 v180, v173, v168
    v_cvt_pk_bf16_f32 v180, v180, v180
    v_lshlrev_b32 v180, 16, v180
    v_mul_f32 v180, v180, v169
    v_cvt_pk_bf16_f32 v180, v180, v180
    v_lshlrev_b32 v180, 16, v180
    v_add_f32 v177, v149, v180
    v_cvt_pk_bf16_f32 v150, v150, v150
    v_lshlrev_b32 v150, 16, v150
    v_add_f32 v150, v174, v150
    v_cvt_pk_bf16_f32 v150, v150, v150
    v_lshlrev_b32 v150, 16, v150
    v_sub_f32 v180, v174, v168
    v_cvt_pk_bf16_f32 v180, v180, v180
    v_lshlrev_b32 v180, 16, v180
    v_mul_f32 v180, v180, v169
    v_cvt_pk_bf16_f32 v180, v180, v180
    v_lshlrev_b32 v180, 16, v180
    v_add_f32 v178, v150, v180
    v_cvt_pk_bf16_f32 v151, v151, v151
    v_lshlrev_b32 v151, 16, v151
    v_add_f32 v151, v175, v151
    v_cvt_pk_bf16_f32 v151, v151, v151
    v_lshlrev_b32 v151, 16, v151
    v_sub_f32 v180, v175, v168
    v_cvt_pk_bf16_f32 v180, v180, v180
    v_lshlrev_b32 v180, 16, v180
    v_mul_f32 v180, v180, v169
    v_cvt_pk_bf16_f32 v180, v180, v180
    v_lshlrev_b32 v180, 16, v180
    v_add_f32 v179, v151, v180
    v_cvt_pk_bf16_f32 v182, v176, v177
    v_cvt_pk_bf16_f32 v183, v178, v179
    buffer_store_dwordx2 v[182:183], v10, s[24:27], 0 offen offset:96
    s_mov_b64 exec, s[48:49]
    s_endpgm
k3_ffn:
    s_sub_u32 s3, s2, 224
    s_cmp_ge_u32 s3, 28
    s_cbranch_scc1 k3_done
    s_load_dwordx2 s[4:5], s[0:1], 80
    s_load_dwordx2 s[6:7], s[0:1], 16
    s_load_dwordx2 s[8:9], s[0:1], 0
    s_load_dwordx2 s[10:11], s[0:1], 64
    s_load_dwordx2 s[36:37], s[0:1], 56
    v_and_b32 v1, 1, v0
    v_lshrrev_b32 v2, 1, v0
    s_waitcnt lgkmcnt(0)
    s_mov_b32 s12, s4
    s_mov_b32 s13, s5
    s_mov_b32 s14, 0x70b000
    s_mov_b32 s15, 0x00020000
    s_mov_b32 s16, s6
    s_mov_b32 s17, s7
    s_mov_b32 s18, 0x62000
    s_mov_b32 s19, 0x00020000
    s_mov_b32 s20, s8
    s_mov_b32 s21, s9
    s_mov_b32 s22, 0x1c0000
    s_mov_b32 s23, 0x00020000
    s_mov_b32 s24, s10
    s_mov_b32 s25, s11
    s_mov_b32 s26, 0x1c0000
    s_mov_b32 s27, 0x00020000
    s_mov_b32 s28, s36
    s_mov_b32 s29, s37
    s_mov_b32 s30, 0x188000
    s_mov_b32 s31, 0x00020000
    s_add_u32 s50, s4, 7380992
    s_addc_u32 s51, s5, 0
    s_load_dwordx4 s[40:43], s[50:51], 0
    v_mul_u32_u24 v3, 896, v2
    v_lshl_add_u32 v3, v1, 4, v3
    s_lshl_b32 s33, s3, 5
    s_add_u32 s34, s33, 0
    buffer_load_dwordx4 v[112:115], v3, s[28:31], s34 offen
    s_add_u32 s34, s33, 114688
    buffer_load_dwordx4 v[116:119], v3, s[28:31], s34 offen
    s_add_u32 s34, s33, 229376
    buffer_load_dwordx4 v[120:123], v3, s[28:31], s34 offen
    s_add_u32 s34, s33, 344064
    buffer_load_dwordx4 v[124:127], v3, s[28:31], s34 offen
    s_add_u32 s34, s33, 458752
    buffer_load_dwordx4 v[128:131], v3, s[28:31], s34 offen
    s_add_u32 s34, s33, 573440
    buffer_load_dwordx4 v[132:135], v3, s[28:31], s34 offen
    s_add_u32 s34, s33, 688128
    buffer_load_dwordx4 v[136:139], v3, s[28:31], s34 offen
    s_add_u32 s34, s33, 802816
    buffer_load_dwordx4 v[140:143], v3, s[28:31], s34 offen
    s_add_u32 s34, s33, 917504
    buffer_load_dwordx4 v[144:147], v3, s[28:31], s34 offen
    s_add_u32 s34, s33, 1032192
    buffer_load_dwordx4 v[148:151], v3, s[28:31], s34 offen
    s_add_u32 s34, s33, 1146880
    buffer_load_dwordx4 v[152:155], v3, s[28:31], s34 offen
    s_add_u32 s34, s33, 1261568
    buffer_load_dwordx4 v[156:159], v3, s[28:31], s34 offen
    s_add_u32 s34, s33, 1376256
    buffer_load_dwordx4 v[160:163], v3, s[28:31], s34 offen
    s_add_u32 s34, s33, 1490944
    buffer_load_dwordx4 v[164:167], v3, s[28:31], s34 offen
    s_add_u32 s34, s33, 0
    buffer_load_dwordx4 v[168:171], v3, s[16:19], s34 offen
    s_add_u32 s34, s33, 114688
    buffer_load_dwordx4 v[172:175], v3, s[16:19], s34 offen
    s_add_u32 s34, s33, 229376
    buffer_load_dwordx4 v[176:179], v3, s[16:19], s34 offen
    s_add_u32 s34, s33, 344064
    buffer_load_dwordx4 v[180:183], v3, s[16:19], s34 offen
    v_lshlrev_b32 v4, 4, v0
    s_mov_b32 s35, 7372800
    s_add_u32 s38, s35, 3584
    buffer_load_dwordx4 v[32:35], v4, s[12:15], s35 offen
    buffer_load_dwordx4 v[36:39], v4, s[12:15], s38 offen
    s_waitcnt lgkmcnt(0)
    s_mul_i32 s44, s40, 896
    s_add_u32 s44, s44, 5537792
    s_mul_i32 s45, s41, 896
    s_add_u32 s45, s45, 5537792
    buffer_load_dwordx4 v[40:43], v4, s[12:15], s44 offen
    buffer_load_dwordx4 v[44:47], v4, s[12:15], s45 offen
    v_lshrrev_b32 v10, 4, v0
    v_and_b32 v11, 15, v0
    s_lshl_b32 s48, s3, 4
    v_add_u32 v11, s48, v11
    v_cmp_eq_u32 vcc, 0, v10
    v_mov_b32 v12, s41
    v_mov_b32 v13, s40
    v_cndmask_b32 v12, v12, v13, vcc
    v_mov_b32 v13, s43
    v_mov_b32 v14, s42
    v_cndmask_b32 v13, v13, v14, vcc
    v_and_b32 v12, 2047, v12
    v_mul_u32_u24 v14, 896, v12
    v_lshl_add_u32 v14, v11, 1, v14
    buffer_load_ushort v15, v14, s[20:23], 0 offen
    v_lshlrev_b32 v16, 3, v12
    s_mov_b32 s49, 5505024
    buffer_load_dwordx2 v[18:19], v16, s[12:15], s49 offen
    v_lshlrev_b32 v5, 5, v2
    v_lshl_add_u32 v5, v1, 4, v5
    s_waitcnt vmcnt(23)
    ds_write_b128 v5, v[112:115] offset:0
    s_waitcnt vmcnt(22)
    ds_write_b128 v5, v[116:119] offset:4096
    s_waitcnt vmcnt(21)
    ds_write_b128 v5, v[120:123] offset:8192
    s_waitcnt vmcnt(20)
    ds_write_b128 v5, v[124:127] offset:12288
    s_waitcnt vmcnt(19)
    ds_write_b128 v5, v[128:131] offset:16384
    s_waitcnt vmcnt(18)
    ds_write_b128 v5, v[132:135] offset:20480
    s_waitcnt vmcnt(17)
    ds_write_b128 v5, v[136:139] offset:24576
    s_waitcnt vmcnt(16)
    ds_write_b128 v5, v[140:143] offset:28672
    s_waitcnt vmcnt(15)
    ds_write_b128 v5, v[144:147] offset:32768
    s_waitcnt vmcnt(14)
    ds_write_b128 v5, v[148:151] offset:36864
    s_waitcnt vmcnt(13)
    ds_write_b128 v5, v[152:155] offset:40960
    s_waitcnt vmcnt(12)
    ds_write_b128 v5, v[156:159] offset:45056
    s_waitcnt vmcnt(11)
    ds_write_b128 v5, v[160:163] offset:49152
    s_waitcnt vmcnt(10)
    ds_write_b128 v5, v[164:167] offset:53248
    v_add_u32 v17, 57344, v5
    s_waitcnt vmcnt(9)
    ds_write_b128 v17, v[168:171] offset:0
    s_waitcnt vmcnt(8)
    ds_write_b128 v17, v[172:175] offset:4096
    s_waitcnt vmcnt(7)
    ds_write_b128 v17, v[176:179] offset:8192
    s_waitcnt vmcnt(6)
    ds_write_b128 v17, v[180:183] offset:12288
    v_add_u32 v6, 73728, v4
    v_cmp_gt_u32 vcc, 224, v0
    s_and_saveexec_b64 s[46:47], vcc
    s_waitcnt vmcnt(5)
    ds_write_b128 v6, v[32:35]
    s_waitcnt vmcnt(4)
    ds_write_b128 v6, v[36:39] offset:4608
    s_mov_b64 exec, s[46:47]
    v_cmp_gt_u32 vcc, 64, v0
    s_and_saveexec_b64 s[46:47], vcc
    s_waitcnt vmcnt(3)
    ds_write_b128 v6, v[40:43] offset:3584
    s_waitcnt vmcnt(2)
    ds_write_b128 v6, v[44:47] offset:8192
    s_mov_b64 exec, s[46:47]
    s_waitcnt lgkmcnt(0)
    s_barrier
    v_lshrrev_b32 v7, 6, v0
    s_nop 0
    v_readfirstlane_b32 s28, v7
    v_and_b32 v20, 63, v0
    v_and_b32 v21, 15, v0
    v_bfe_u32 v22, v0, 4, 2
    v_bfe_u32 v23, v0, 2, 4
    v_lshlrev_b32 v23, 5, v23
    v_and_b32 v24, 3, v0
    v_lshl_add_u32 v23, v24, 3, v23
    s_lshl_b32 s52, s28, 10
    v_add_u32 v23, s52, v23
    v_mul_u32_u24 v25, 4608, v21
    v_lshl_add_u32 v25, v22, 3, v25
    s_lshl_b32 s53, s28, 6
    s_add_u32 s53, s53, 73728
    v_add_u32 v25, s53, v25
    v_mov_b32 v32, 0
    v_mov_b32 v33, 0
    v_mov_b32 v34, 0
    v_mov_b32 v35, 0
    v_mov_b32 v36, 0
    v_mov_b32 v37, 0
    v_mov_b32 v38, 0
    v_mov_b32 v39, 0
    v_mov_b32 v40, 0
    v_mov_b32 v41, 0
    v_mov_b32 v42, 0
    v_mov_b32 v43, 0
    v_mov_b32 v44, 0
    v_mov_b32 v45, 0
    v_mov_b32 v46, 0
    v_mov_b32 v47, 0
    v_mov_b32 v48, 0
    v_mov_b32 v49, 0
    v_mov_b32 v50, 0
    v_mov_b32 v51, 0
    v_mov_b32 v52, 0
    v_mov_b32 v53, 0
    v_mov_b32 v54, 0
    v_mov_b32 v55, 0
    v_mov_b32 v56, 0
    v_mov_b32 v57, 0
    v_mov_b32 v58, 0
    v_mov_b32 v59, 0
    v_mov_b32 v60, 0
    v_mov_b32 v61, 0
    v_mov_b32 v62, 0
    v_mov_b32 v63, 0
    v_mov_b32 v64, 0
    v_mov_b32 v65, 0
    v_mov_b32 v66, 0
    v_mov_b32 v67, 0
    v_mov_b32 v68, 0
    v_mov_b32 v69, 0
    v_mov_b32 v70, 0
    v_mov_b32 v71, 0
    v_mov_b32 v72, 0
    v_mov_b32 v73, 0
    v_mov_b32 v74, 0
    v_mov_b32 v75, 0
    v_mov_b32 v76, 0
    v_mov_b32 v77, 0
    v_mov_b32 v78, 0
    v_mov_b32 v79, 0
    v_mov_b32 v80, 0
    v_mov_b32 v81, 0
    v_mov_b32 v82, 0
    v_mov_b32 v83, 0
    v_mov_b32 v84, 0
    v_mov_b32 v85, 0
    v_mov_b32 v86, 0
    v_mov_b32 v87, 0
    v_mov_b32 v88, 0
    v_mov_b32 v89, 0
    v_mov_b32 v90, 0
    v_mov_b32 v91, 0
    v_mov_b32 v92, 0
    v_mov_b32 v93, 0
    v_mov_b32 v94, 0
    v_mov_b32 v95, 0
    v_mov_b32 v96, 0
    v_mov_b32 v97, 0
    v_mov_b32 v98, 0
    v_mov_b32 v99, 0
    v_mov_b32 v100, 0
    v_mov_b32 v101, 0
    v_mov_b32 v102, 0
    v_mov_b32 v103, 0
    v_cmp_gt_u32 vcc, 2, v21
    s_and_saveexec_b64 s[46:47], vcc
    ds_read_b64 v[32:33], v25 offset:0
    ds_read_b64 v[34:35], v25 offset:32
    ds_read_b64 v[36:37], v25 offset:256
    ds_read_b64 v[38:39], v25 offset:288
    ds_read_b64 v[40:41], v25 offset:512
    ds_read_b64 v[42:43], v25 offset:544
    ds_read_b64 v[44:45], v25 offset:768
    ds_read_b64 v[46:47], v25 offset:800
    ds_read_b64 v[48:49], v25 offset:1024
    ds_read_b64 v[50:51], v25 offset:1056
    ds_read_b64 v[52:53], v25 offset:1280
    ds_read_b64 v[54:55], v25 offset:1312
    ds_read_b64 v[56:57], v25 offset:1536
    ds_read_b64 v[58:59], v25 offset:1568
    ds_read_b64 v[60:61], v25 offset:1792
    ds_read_b64 v[62:63], v25 offset:1824
    ds_read_b64 v[64:65], v25 offset:2048
    ds_read_b64 v[66:67], v25 offset:2080
    ds_read_b64 v[68:69], v25 offset:2304
    ds_read_b64 v[70:71], v25 offset:2336
    ds_read_b64 v[72:73], v25 offset:2560
    ds_read_b64 v[74:75], v25 offset:2592
    ds_read_b64 v[76:77], v25 offset:2816
    ds_read_b64 v[78:79], v25 offset:2848
    ds_read_b64 v[80:81], v25 offset:3072
    ds_read_b64 v[82:83], v25 offset:3104
    ds_read_b64 v[84:85], v25 offset:3328
    ds_read_b64 v[86:87], v25 offset:3360
    ds_read_b64 v[88:89], v25 offset:3584
    ds_read_b64 v[90:91], v25 offset:3616
    ds_read_b64 v[92:93], v25 offset:3840
    ds_read_b64 v[94:95], v25 offset:3872
    ds_read_b64 v[96:97], v25 offset:4096
    ds_read_b64 v[98:99], v25 offset:4128
    ds_read_b64 v[100:101], v25 offset:4352
    ds_read_b64 v[102:103], v25 offset:4384
    s_mov_b64 exec, s[46:47]
    v_add_u32 v28, 57344, v23
    ds_read_b64_tr_b16 v[112:113], v23 offset:0
    ds_read_b64_tr_b16 v[114:115], v23 offset:512
    ds_read_b64_tr_b16 v[116:117], v23 offset:4096
    ds_read_b64_tr_b16 v[118:119], v23 offset:4608
    ds_read_b64_tr_b16 v[120:121], v23 offset:8192
    ds_read_b64_tr_b16 v[122:123], v23 offset:8704
    ds_read_b64_tr_b16 v[124:125], v23 offset:12288
    ds_read_b64_tr_b16 v[126:127], v23 offset:12800
    ds_read_b64_tr_b16 v[128:129], v23 offset:16384
    ds_read_b64_tr_b16 v[130:131], v23 offset:16896
    ds_read_b64_tr_b16 v[132:133], v23 offset:20480
    ds_read_b64_tr_b16 v[134:135], v23 offset:20992
    ds_read_b64_tr_b16 v[136:137], v23 offset:24576
    ds_read_b64_tr_b16 v[138:139], v23 offset:25088
    ds_read_b64_tr_b16 v[140:141], v23 offset:28672
    ds_read_b64_tr_b16 v[142:143], v23 offset:29184
    ds_read_b64_tr_b16 v[144:145], v23 offset:32768
    ds_read_b64_tr_b16 v[146:147], v23 offset:33280
    ds_read_b64_tr_b16 v[148:149], v23 offset:36864
    ds_read_b64_tr_b16 v[150:151], v23 offset:37376
    ds_read_b64_tr_b16 v[152:153], v23 offset:40960
    ds_read_b64_tr_b16 v[154:155], v23 offset:41472
    ds_read_b64_tr_b16 v[156:157], v23 offset:45056
    ds_read_b64_tr_b16 v[158:159], v23 offset:45568
    ds_read_b64_tr_b16 v[160:161], v23 offset:49152
    ds_read_b64_tr_b16 v[162:163], v23 offset:49664
    ds_read_b64_tr_b16 v[164:165], v23 offset:53248
    ds_read_b64_tr_b16 v[166:167], v23 offset:53760
    ds_read_b64_tr_b16 v[168:169], v28 offset:0
    ds_read_b64_tr_b16 v[170:171], v28 offset:512
    ds_read_b64_tr_b16 v[172:173], v28 offset:4096
    ds_read_b64_tr_b16 v[174:175], v28 offset:4608
    ds_read_b64_tr_b16 v[176:177], v28 offset:8192
    ds_read_b64_tr_b16 v[178:179], v28 offset:8704
    ds_read_b64_tr_b16 v[180:181], v28 offset:12288
    ds_read_b64_tr_b16 v[182:183], v28 offset:12800
    v_mov_b32 v104, 0
    v_mov_b32 v105, 0
    v_mov_b32 v106, 0
    v_mov_b32 v107, 0
    v_mov_b32 v108, 0
    v_mov_b32 v109, 0
    v_mov_b32 v110, 0
    v_mov_b32 v111, 0
    s_waitcnt lgkmcnt(15)
    v_mfma_f32_16x16x32_bf16 v[104:107], v[112:115], v[32:35], v[104:107]
    s_nop 7
    v_mfma_f32_16x16x32_bf16 v[104:107], v[116:119], v[36:39], v[104:107]
    s_nop 7
    v_mfma_f32_16x16x32_bf16 v[104:107], v[120:123], v[40:43], v[104:107]
    s_nop 7
    v_mfma_f32_16x16x32_bf16 v[104:107], v[124:127], v[44:47], v[104:107]
    s_nop 7
    v_mfma_f32_16x16x32_bf16 v[104:107], v[128:131], v[48:51], v[104:107]
    s_nop 7
    v_mfma_f32_16x16x32_bf16 v[104:107], v[132:135], v[52:55], v[104:107]
    s_nop 7
    v_mfma_f32_16x16x32_bf16 v[104:107], v[136:139], v[56:59], v[104:107]
    s_nop 7
    v_mfma_f32_16x16x32_bf16 v[104:107], v[140:143], v[60:63], v[104:107]
    s_nop 7
    v_mfma_f32_16x16x32_bf16 v[104:107], v[144:147], v[64:67], v[104:107]
    s_nop 7
    v_mfma_f32_16x16x32_bf16 v[104:107], v[148:151], v[68:71], v[104:107]
    s_waitcnt lgkmcnt(14)
    s_nop 6
    v_mfma_f32_16x16x32_bf16 v[104:107], v[152:155], v[72:75], v[104:107]
    s_waitcnt lgkmcnt(12)
    s_nop 6
    v_mfma_f32_16x16x32_bf16 v[104:107], v[156:159], v[76:79], v[104:107]
    s_waitcnt lgkmcnt(10)
    s_nop 6
    v_mfma_f32_16x16x32_bf16 v[104:107], v[160:163], v[80:83], v[104:107]
    s_waitcnt lgkmcnt(8)
    s_nop 6
    v_mfma_f32_16x16x32_bf16 v[104:107], v[164:167], v[84:87], v[104:107]
    s_waitcnt lgkmcnt(6)
    v_mfma_f32_16x16x32_bf16 v[108:111], v[168:171], v[88:91], v[108:111]
    s_waitcnt lgkmcnt(4)
    s_nop 6
    v_mfma_f32_16x16x32_bf16 v[108:111], v[172:175], v[92:95], v[108:111]
    s_waitcnt lgkmcnt(2)
    s_nop 6
    v_mfma_f32_16x16x32_bf16 v[108:111], v[176:179], v[96:99], v[108:111]
    s_waitcnt lgkmcnt(0)
    s_nop 6
    v_mfma_f32_16x16x32_bf16 v[108:111], v[180:183], v[100:103], v[108:111]
    v_lshlrev_b32 v26, 6, v21
    v_lshl_add_u32 v26, v22, 4, v26
    s_lshl_b32 s54, s28, 8
    s_add_u32 s54, s54, 83968
    v_add_u32 v26, s54, v26
    v_cmp_gt_u32 vcc, 2, v21
    s_and_saveexec_b64 s[46:47], vcc
    ds_write_b128 v26, v[104:107]
    ds_write_b128 v26, v[108:111] offset:128
    s_mov_b64 exec, s[46:47]
    s_waitcnt lgkmcnt(0)
    s_barrier
    v_cmp_gt_u32 vcc, 32, v0
    s_and_saveexec_b64 s[46:47], vcc
    s_cbranch_execz k3_done
    v_lshlrev_b32 v27, 2, v0
    v_add_u32 v27, 83968, v27
    ds_read_b32 v64, v27 offset:0
    ds_read_b32 v68, v27 offset:128
    ds_read_b32 v65, v27 offset:256
    ds_read_b32 v69, v27 offset:384
    ds_read_b32 v66, v27 offset:512
    ds_read_b32 v70, v27 offset:640
    ds_read_b32 v67, v27 offset:768
    ds_read_b32 v71, v27 offset:896
    s_waitcnt lgkmcnt(5)
    v_add_f32 v8, v64, v65
    s_waitcnt lgkmcnt(3)
    v_add_f32 v8, v8, v66
    s_waitcnt lgkmcnt(1)
    v_add_f32 v8, v8, v67
    v_add_f32 v9, v68, v69
    v_add_f32 v9, v9, v70
    s_waitcnt lgkmcnt(0)
    v_add_f32 v9, v9, v71
    s_waitcnt vmcnt(1)
    v_lshlrev_b32 v15, 16, v15
    v_cvt_pk_bf16_f32 v8, v8, v8
    v_lshlrev_b32 v8, 16, v8
    v_mul_f32 v8, v8, v13
    v_cvt_pk_bf16_f32 v8, v8, v8
    v_lshlrev_b32 v8, 16, v8
    v_cvt_pk_bf16_f32 v9, v9, v9
    v_lshlrev_b32 v9, 16, v9
    v_add_f32 v9, v15, v9
    v_cvt_pk_bf16_f32 v9, v9, v9
    v_lshlrev_b32 v9, 16, v9
    s_waitcnt vmcnt(0)
    v_sub_f32 v21, v15, v18
    v_cvt_pk_bf16_f32 v21, v21, v21
    v_lshlrev_b32 v21, 16, v21
    v_mul_f32 v21, v21, v19
    v_cvt_pk_bf16_f32 v21, v21, v21
    v_lshlrev_b32 v21, 16, v21
    v_add_f32 v21, v21, v8
    v_cvt_pk_bf16_f32 v21, v21, v21
    v_lshlrev_b32 v21, 16, v21
    v_add_f32 v20, v9, v21
    v_cvt_pk_bf16_f32 v20, v20, v20
    buffer_store_short v20, v14, s[24:27], 0 offen
    s_waitcnt vmcnt(0)
k3_done:
    s_endpgm
.section .rodata,"a"
.p2align 6
.amdhsa_kernel k3_kernel
  .amdhsa_next_free_vgpr 184
  .amdhsa_next_free_sgpr 96
  .amdhsa_accum_offset 184
  .amdhsa_group_segment_fixed_size 0
  .amdhsa_kernarg_size 88
  .amdhsa_user_sgpr_count 2
  .amdhsa_user_sgpr_kernarg_segment_ptr 1
  .amdhsa_system_sgpr_workgroup_id_x 1
.end_amdhsa_kernel
```
